```python
import torch

def _softmax(x, axis=-1):
    return torch.softmax(x, dim=axis)

def _gelu(x):
    return torch.nn.functional.gelu(x, approximate='tanh')

def _silu(x):
    return torch.nn.functional.silu(x)

def _sigmoid(x):
    return torch.sigmoid(x)

def _layernorm(x, axis=-1, eps=1e-05):
    m = x.mean(dim=axis, keepdim=True)
    v = x.var(dim=axis, keepdim=True, unbiased=False)
    return (x - m) / torch.sqrt(v + eps)

def _scatter_add(tgt, idx, src, axis=0):
    return tgt.clone().index_add_(axis, idx, src)

def _segment_sum(src, seg, n):
    out = torch.zeros((n,) + src.shape[1:], dtype=src.dtype)
    return out.index_add_(0, seg, src)

def _pad(x, pw):
    flat = tuple((v for pair in reversed(pw) for v in pair))
    return torch.nn.functional.pad(x, flat)
kernel_name = 'recurrent_scan__spectral_fnet__mixer_gmlp__prompt'

def setup_inputs():

    _w = lambda a: (lambda t: t.to(torch.bfloat16) if t.is_floating_point() else t)(torch.as_tensor(a))

    def _A_setup():
        B, S, D = (1, 2048, 512)
        ns = torch.arange(S)[:, None] * torch.arange(S)[None, :]
        nd = torch.arange(D)[:, None] * torch.arange(D)[None, :]
        Ws_re = torch.cos(-2.0 * torch.pi * ns / S).to(float)
        Ws_im = torch.sin(-2.0 * torch.pi * ns / S).to(float)
        Wd_re = torch.cos(-2.0 * torch.pi * nd / D).to(float)
        Wd_im = torch.sin(-2.0 * torch.pi * nd / D).to(float)
        return {'x': _w((lambda *s: torch.randn(*s, dtype=torch.bfloat16) * 0.05)(B, S, D)), 'dft_seq_re': _w(Ws_re), 'dft_seq_im': _w(Ws_im), 'dft_hid_re': _w(Wd_re), 'dft_hid_im': _w(Wd_im)}
    _A_in = _A_setup()

    def _B_setup():
        B, S, D, F = (1, 2048, 512, 1376)
        Fh = F // 2
        return {'x': _w((lambda *s: torch.randn(*s, dtype=torch.bfloat16) * 0.05)(B, S, D)), 'w_in': _w((lambda *s: torch.randn(*s, dtype=torch.bfloat16) * 0.4)(D, 2 * Fh)), 'w_sp': _w(0.01 * (lambda *s: torch.randn(*s, dtype=torch.bfloat16) * 0.4)(S, S)), 'b_sp': _w(1.0 + 0.01 * (lambda *s: torch.randn(*s, dtype=torch.bfloat16) * 0.05)(S)), 'w_out': _w((lambda *s: torch.randn(*s, dtype=torch.bfloat16) * 0.05)(Fh, D))}
    _B_in = _B_setup()
    return {'A_x': _A_in['x'], 'A_dft_seq_re': _A_in['dft_seq_re'], 'A_dft_seq_im': _A_in['dft_seq_im'], 'A_dft_hid_re': _A_in['dft_hid_re'], 'A_dft_hid_im': _A_in['dft_hid_im'], 'B_x': _B_in['x'], 'B_w_in': _B_in['w_in'], 'B_w_sp': _B_in['w_sp'], 'B_b_sp': _B_in['b_sp'], 'B_w_out': _B_in['w_out']}

def reference(A_x, A_dft_seq_re, A_dft_seq_im, A_dft_hid_re, A_dft_hid_im, B_x, B_w_in, B_w_sp, B_b_sp, B_w_out):

    def _A_ref(x, dft_seq_re, dft_seq_im, dft_hid_re, dft_hid_im):
        a = torch.einsum('bsd,ed->bse', x, dft_hid_re)
        b = torch.einsum('bsd,ed->bse', x, dft_hid_im)
        y = torch.einsum('ts,bse->bte', dft_seq_re, a) - torch.einsum('ts,bse->bte', dft_seq_im, b)
        return y

    def _B_ref(x, w_in, w_sp, b_sp, w_out):
        B, S, D = x.shape
        F = w_in.shape[-1]
        Fh = F // 2
        z = _gelu(torch.einsum('bsd,df->bsf', x, w_in))
        z1 = z[..., :Fh].clone()
        z2 = _layernorm(z[..., Fh:], axis=-1)
        g = torch.einsum('ts,bsf->btf', w_sp, z2) + b_sp[None, :, None]
        return torch.einsum('bsf,fd->bsd', z1 * g, w_out)
    x = A_x
    xn = _layernorm(x, axis=-1)
    s = _A_ref(xn, A_dft_seq_re, A_dft_seq_im, A_dft_hid_re, A_dft_hid_im)
    g = _silu(_B_ref(xn, B_w_in, B_w_sp, B_b_sp, B_w_out))
    return x + s * g
```

```asm
; @launch grid=(256,1,1) block=(512,1,1) lds=163840
.amdgcn_target "amdgcn-amd-amdhsa--gfx950"
.text
.globl recurrent_scan__spectral_fnet__mixer_gmlp__prompt_kernel
.p2align 8
.type recurrent_scan__spectral_fnet__mixer_gmlp__prompt_kernel,@function
recurrent_scan__spectral_fnet__mixer_gmlp__prompt_kernel:
    s_cmp_ge_u32 s2, 256
    s_cbranch_scc1 L_end
    s_load_dwordx16 s[64:79], s[0:1], 0
    s_load_dwordx8 s[88:95], s[0:1], 64
    s_load_dwordx2 s[96:97], s[0:1], 96
    v_and_b32 v1, 63, v0
    v_lshrrev_b32 v10, 6, v0
    v_lshrrev_b32 v2, 4, v1
    v_readfirstlane_b32 s59, v10
    v_and_b32 v3, 15, v1
    s_and_b32 s3, s2, 7
    s_lshr_b32 s4, s2, 3
    s_lshr_b32 s5, s4, 4
    s_lshl_b32 s60, s3, 1
    s_add_u32 s60, s60, s5
    s_and_b32 s61, s4, 15
    v_and_b32 v10, 7, v1
    v_xor_b32 v10, v10, v2
    v_lshrrev_b32 v11, 3, v1
    v_lshlrev_b32 v32, 10, v11
    v_lshl_add_u32 v16, v10, 4, v32
    v_xor_b32 v33, 4, v10
    v_lshl_add_u32 v17, v33, 4, v32
    v_add_u32 v17, 7168, v17
    v_and_b32 v34, 1, v2
    v_lshlrev_b32 v34, 1, v34
    v_and_b32 v35, 7, v1
    v_xor_b32 v34, v34, v35
    s_and_b32 s5, s59, 1
    s_lshl_b32 s5, s5, 2
    v_xor_b32 v34, s5, v34
    v_lshlrev_b32 v34, 4, v34
    s_lshl_b32 s86, s59, 11
    s_lshl_b32 s84, s59, 10
    s_lshl_b32 s80, s60, 17
    s_lshl_b32 s5, s59, 14
    s_add_u32 s80, s80, s5
    s_cmp_lt_u32 s61, 12
    s_cselect_b32 s81, 0, 1
    s_add_u32 s4, s61, 10
    s_sub_u32 s5, s61, 12
    s_cmp_lt_u32 s61, 12
    s_cselect_b32 s82, s4, s5
    s_cmp_lt_u32 s61, 5
    s_cselect_b32 s83, 1, 2
    s_add_u32 s4, s61, 4
    s_sub_u32 s5, s61, 5
    s_cmp_lt_u32 s61, 5
    s_cselect_b32 s85, s4, s5
    s_waitcnt lgkmcnt(0)
    s_mov_b32 s8, s64
    s_mov_b32 s9, s65
    s_mov_b32 s10, 2097152
    s_mov_b32 s11, 0x00020000
    s_mov_b32 s68, s80
    s_mov_b32 s48, s70
    s_mov_b32 s49, s71
    s_mov_b32 s50, s72
    s_mov_b32 s51, s73
    s_mov_b32 s52, s76
    s_mov_b32 s53, s77
    s_mov_b32 s24, s78
    s_mov_b32 s25, s79
    s_mov_b32 s26, 8388608
    s_mov_b32 s27, 0x00020000
    s_add_u32 m0, s86, 0
    s_nop 0
    buffer_load_dwordx4 v16, s[8:11], s68 offen offset:0 lds
    buffer_load_dwordx4 v17, s[8:11], s68 offen offset:1024 lds
    s_add_u32 s68, s68, 128
    s_mov_b32 s74, s81
    s_mov_b32 s76, s82
    s_mov_b32 s75, s83
    s_mov_b32 s77, s85
    s_cmp_eq_u32 s74, 0
    s_cselect_b32 s12, s52, s48
    s_cselect_b32 s13, s53, s49
    s_mov_b32 s4, 524288
    s_cselect_b32 s14, 1409024, s4
    s_mov_b32 s4, 1024
    s_cselect_b32 s7, 2752, s4
    s_mov_b32 s15, 0x00020000
    s_lshl_b32 s6, s76, 7
    v_mul_lo_u32 v20, v11, s7
    v_add_u32 v20, v20, v34
    s_lshl_b32 s5, s7, 3
    s_mul_i32 s70, s5, s59
    s_add_u32 s70, s70, s6
    s_lshl_b32 s72, s7, 6
    s_add_u32 m0, s84, 65536
    s_nop 0
    buffer_load_dwordx4 v20, s[12:15], s70 offen lds
    s_add_u32 s70, s70, s72
    s_cmp_eq_u32 s77, 4
    s_cselect_b32 s44, s48, s50
    s_cselect_b32 s45, s49, s51
    s_sub_u32 s6, s77, 5
    s_lshl_b32 s6, s6, 7
    s_cmp_eq_u32 s77, 4
    s_cselect_b32 s6, 512, s6
    s_lshl_b32 s4, s77, 7
    s_cmp_eq_u32 s75, 2
    s_cselect_b32 s6, s4, s6
    s_cselect_b32 s44, s52, s44
    s_cselect_b32 s45, s53, s45
    s_mov_b32 s4, 524288
    s_cselect_b32 s46, 1409024, s4
    s_mov_b32 s4, 1024
    s_cselect_b32 s7, 2752, s4
    s_mov_b32 s47, 0x00020000
    v_mul_lo_u32 v21, v11, s7
    v_add_u32 v21, v21, v34
    s_lshl_b32 s5, s7, 3
    s_mul_i32 s71, s5, s59
    s_add_u32 s71, s71, s6
    s_lshl_b32 s73, s7, 6
    s_add_u32 m0, s84, 98304
    s_nop 0
    buffer_load_dwordx4 v21, s[44:47], s71 offen lds
    s_add_u32 s71, s71, s73
    s_barrier
    s_add_u32 m0, s86, 16384
    s_nop 0
    buffer_load_dwordx4 v16, s[8:11], s68 offen offset:0 lds
    buffer_load_dwordx4 v17, s[8:11], s68 offen offset:1024 lds
    s_add_u32 s68, s68, 128
    s_add_u32 m0, s84, 73728
    s_nop 0
    buffer_load_dwordx4 v20, s[12:15], s70 offen lds
    s_add_u32 s70, s70, s72
    s_add_u32 m0, s84, 106496
    s_nop 0
    buffer_load_dwordx4 v21, s[44:47], s71 offen lds
    s_add_u32 s71, s71, s73
    s_add_u32 m0, s86, 32768
    s_nop 0
    buffer_load_dwordx4 v16, s[8:11], s68 offen offset:0 lds
    buffer_load_dwordx4 v17, s[8:11], s68 offen offset:1024 lds
    s_add_u32 s68, s68, 128
    s_add_u32 m0, s84, 81920
    s_nop 0
    buffer_load_dwordx4 v20, s[12:15], s70 offen lds
    s_add_u32 s70, s70, s72
    s_add_u32 m0, s84, 114688
    s_nop 0
    buffer_load_dwordx4 v21, s[44:47], s71 offen lds
    s_add_u32 s71, s71, s73
    s_mov_b32 s16, s96
    s_mov_b32 s17, s97
    s_mov_b32 s18, 268435456
    s_mov_b32 s19, 0x00020000
    v_mov_b32 v10, 0
    buffer_load_dword v127, v10, s[16:19], 0 offen sc1
    s_add_u32 s20, s96, 2097152
    s_addc_u32 s21, s97, 0
    s_mov_b32 s22, 2818048
    s_mov_b32 s23, 0x00020000
    s_mov_b32 s28, s92
    s_mov_b32 s29, s93
    s_mov_b32 s30, 2097152
    s_mov_b32 s31, 0x00020000
    s_mov_b32 s32, s90
    s_mov_b32 s33, s91
    s_mov_b32 s34, 704512
    s_mov_b32 s35, 0x00020000
    s_mov_b32 s36, s48
    s_mov_b32 s37, s49
    s_mov_b32 s38, 524288
    s_mov_b32 s39, 0x00020000
    s_mov_b32 s40, s50
    s_mov_b32 s41, s51
    s_mov_b32 s42, 524288
    s_mov_b32 s43, 0x00020000
    s_mov_b32 s54, s88
    s_mov_b32 s55, s89
    s_mov_b32 s56, s94
    s_mov_b32 s57, s95
    s_lshr_b32 s4, s2, 3
    s_and_b32 s3, s2, 7
    s_lshr_b32 s5, s4, 3
    s_lshl_b32 s62, s3, 2
    s_add_u32 s62, s62, s5
    s_and_b32 s63, s4, 7
    v_lshrrev_b32 v32, 1, v3
    v_and_b32 v32, 7, v32
    v_xor_b32 v33, v2, v32
    v_lshlrev_b32 v34, 7, v3
    v_add_u32 v34, s86, v34
    v_lshl_add_u32 v18, v33, 4, v34
    v_xor_b32 v33, 4, v33
    v_lshl_add_u32 v19, v33, 4, v34
    v_lshrrev_b32 v32, 3, v3
    v_and_b32 v33, 1, v2
    v_lshl_or_b32 v32, v33, 1, v32
    v_lshrrev_b32 v33, 2, v3
    v_lshl_add_u32 v33, v2, 3, v33
    v_lshlrev_b32 v33, 7, v33
    v_and_b32 v34, 3, v3
    v_lshl_add_u32 v33, v34, 3, v33
    v_add_u32 v33, 65536, v33
    v_mul_u32_u24 v35, 1088, v2
    v_lshl_add_u32 v35, v3, 1, v35
    s_lshl_b32 s4, s59, 5
    s_add_u32 s4, s4, 132096
    v_add_u32 v35, s4, v35
    s_add_u32 s64, s59, 0
    s_and_b32 s64, s64, 3
    v_xor_b32 v34, s64, v32
    v_lshl_add_u32 v22, v34, 5, v33
    s_mul_i32 s4, s64, 4352
    v_add_u32 v26, s4, v35
    s_add_u32 s65, s59, 1
    s_and_b32 s65, s65, 3
    v_xor_b32 v34, s65, v32
    v_lshl_add_u32 v23, v34, 5, v33
    s_mul_i32 s4, s65, 4352
    v_add_u32 v27, s4, v35
    s_add_u32 s66, s59, 2
    s_and_b32 s66, s66, 3
    v_xor_b32 v34, s66, v32
    v_lshl_add_u32 v24, v34, 5, v33
    s_mul_i32 s4, s66, 4352
    v_add_u32 v28, s4, v35
    s_add_u32 s67, s59, 3
    s_and_b32 s67, s67, 3
    v_xor_b32 v34, s67, v32
    v_lshl_add_u32 v25, v34, 5, v33
    s_mul_i32 s4, s67, 4352
    v_add_u32 v29, s4, v35
    v_mov_b32 v76, 0x3f803f80
    v_mov_b32 v77, 0x3f803f80
    v_mov_b32 v78, 0x3f803f80
    v_mov_b32 v79, 0x3f803f80
    s_lshl_b32 s4, s59, 3
    v_add_u32 v32, s4, v2
    v_mul_u32_u24 v33, 272, v32
    v_lshl_add_u32 v33, v3, 4, v33
    v_add_u32 v30, 132096, v33
    v_lshlrev_b32 v32, 12, v2
    v_lshl_add_u32 v31, v3, 4, v32
    v_lshlrev_b32 v32, 4, v2
    v_add_u32 v14, 131072, v32
    s_lshl_b32 s4, s59, 11
    s_add_u32 s4, s4, 132096
    v_lshlrev_b32 v32, 7, v3
    v_add_u32 v15, s4, v32
    v_lshrrev_b32 v32, 3, v1
    v_and_b32 v33, 7, v1
    v_xor_b32 v34, v33, v32
    v_lshlrev_b32 v35, 7, v32
    v_lshl_add_u32 v35, v34, 4, v35
    v_add_u32 v12, s4, v35
    v_mul_u32_u24 v32, 1408, v32
    v_lshl_add_u32 v13, v33, 4, v32
    v_mov_b32 v4, 3222493025
    v_mov_b32 v5, 3184710632
    v_and_b32 v32, 7, v1
    v_lshrrev_b32 v33, 4, v1
    v_xor_b32 v32, v32, v33
    v_lshrrev_b32 v33, 3, v1
    v_lshlrev_b32 v34, 12, v33
    v_lshl_add_u32 v6, v32, 4, v34
    v_xor_b32 v35, 4, v32
    v_lshl_add_u32 v7, v35, 4, v34
    v_add_u32 v7, 31744, v7
    v_and_b32 v32, 31, v1
    v_lshrrev_b32 v33, 1, v32
    v_and_b32 v33, 7, v33
    v_lshrrev_b32 v34, 5, v1
    v_xor_b32 v33, v33, v34
    v_lshlrev_b32 v32, 7, v32
    v_lshl_add_u32 v8, v33, 4, v32
    s_lshr_b32 s4, s59, 2
    s_lshl_b32 s4, s4, 5
    s_lshl_b32 s5, s62, 6
    s_add_u32 s4, s4, s5
    s_lshl_b32 s4, s4, 12
    s_and_b32 s5, s59, 3
    s_lshl_b32 s5, s5, 10
    s_add_u32 s83, s4, s5
    s_lshl_b32 s4, s59, 12
    s_cmp_lt_u32 s59, 4
    s_mov_b32 s82, 8192
    s_cselect_b32 s82, 16384, s82
    s_cselect_b32 s5, 0, 49152
    s_add_u32 s79, s4, s5
    s_cmp_lt_u32 s59, 6
    s_cselect_b32 s5, 0, 24576
    s_add_u32 s79, s79, s5
    s_waitcnt vmcnt(9)
    s_barrier
    ds_read_b128 a[64:67], v18 offset:0
    ds_read_b128 a[68:71], v19 offset:0
    ds_read_b64_tr_b16 a[0:1], v22 offset:0
    ds_read_b64_tr_b16 a[2:3], v22 offset:512
    ds_read_b64_tr_b16 a[4:5], v23 offset:0
    ds_read_b64_tr_b16 a[6:7], v23 offset:512
    ds_read_b64_tr_b16 a[8:9], v24 offset:0
    ds_read_b64_tr_b16 a[10:11], v24 offset:512
    ds_read_b64_tr_b16 a[12:13], v25 offset:0
    ds_read_b64_tr_b16 a[14:15], v25 offset:512
    ds_read_b64_tr_b16 a[16:17], v22 offset:32768
    ds_read_b64_tr_b16 a[18:19], v22 offset:33280
    ds_read_b64_tr_b16 a[20:21], v23 offset:32768
    ds_read_b64_tr_b16 a[22:23], v23 offset:33280
    ds_read_b64_tr_b16 a[24:25], v24 offset:32768
    ds_read_b64_tr_b16 a[26:27], v24 offset:33280
    ds_read_b64_tr_b16 a[28:29], v25 offset:32768
    ds_read_b64_tr_b16 a[30:31], v25 offset:33280
    s_cmp_lt_u32 s59, 4
    s_cbranch_scc0 L_recurrent_scan__spectral_fnet__mixer_gmlp__prompt_st_1
    s_add_u32 m0, s86, 49152
    s_nop 0
    buffer_load_dwordx4 v16, s[8:11], s68 offen offset:0 lds
    buffer_load_dwordx4 v17, s[8:11], s68 offen offset:1024 lds
    s_add_u32 s68, s68, 128
    s_add_u32 m0, s84, 90112
    s_nop 0
    buffer_load_dwordx4 v20, s[12:15], s70 offen lds
    s_add_u32 s70, s70, s72
    s_add_u32 m0, s84, 122880
    s_nop 0
    buffer_load_dwordx4 v21, s[44:47], s71 offen lds
    s_add_u32 s71, s71, s73
L_recurrent_scan__spectral_fnet__mixer_gmlp__prompt_st_1:
    s_waitcnt lgkmcnt(0)
    v_mfma_f32_16x16x32_bf16 v[32:35], a[0:3], a[64:67], 0
    ds_read_b64_tr_b16 a[32:33], v22 offset:4096
    ds_read_b64_tr_b16 a[34:35], v22 offset:4608
    v_mfma_f32_16x16x32_bf16 v[36:39], a[4:7], a[64:67], 0
    ds_read_b64_tr_b16 a[36:37], v23 offset:4096
    ds_read_b64_tr_b16 a[38:39], v23 offset:4608
    v_mfma_f32_16x16x32_bf16 v[40:43], a[8:11], a[64:67], 0
    ds_read_b64_tr_b16 a[40:41], v24 offset:4096
    s_cmp_lt_u32 s59, 4
    s_cbranch_scc1 L_recurrent_scan__spectral_fnet__mixer_gmlp__prompt_st_2
    s_add_u32 m0, s86, 49152
    s_nop 0
    buffer_load_dwordx4 v16, s[8:11], s68 offen offset:0 lds
    buffer_load_dwordx4 v17, s[8:11], s68 offen offset:1024 lds
    s_add_u32 s68, s68, 128
    s_add_u32 m0, s84, 90112
    s_nop 0
    buffer_load_dwordx4 v20, s[12:15], s70 offen lds
    s_add_u32 s70, s70, s72
    s_add_u32 m0, s84, 122880
    s_nop 0
    buffer_load_dwordx4 v21, s[44:47], s71 offen lds
    s_add_u32 s71, s71, s73
L_recurrent_scan__spectral_fnet__mixer_gmlp__prompt_st_2:
    ds_read_b64_tr_b16 a[42:43], v24 offset:4608
    v_mfma_f32_16x16x32_bf16 v[68:71], v[76:79], a[64:67], 0
    ds_read_b64_tr_b16 a[44:45], v25 offset:4096
    ds_read_b64_tr_b16 a[46:47], v25 offset:4608
    v_mfma_f32_16x16x32_bf16 v[44:47], a[12:15], a[64:67], 0
    ds_read_b64_tr_b16 a[48:49], v22 offset:36864
    ds_read_b64_tr_b16 a[50:51], v22 offset:37376
    v_mfma_f32_16x16x32_bf16 v[48:51], a[16:19], a[64:67], 0
    ds_read_b64_tr_b16 a[52:53], v23 offset:36864
    ds_read_b64_tr_b16 a[54:55], v23 offset:37376
    v_mfma_f32_16x16x32_bf16 v[52:55], a[20:23], a[64:67], 0
    ds_read_b64_tr_b16 a[56:57], v24 offset:36864
    ds_read_b64_tr_b16 a[58:59], v24 offset:37376
    v_mfma_f32_16x16x32_bf16 v[72:75], a[64:67], a[64:67], 0
    ds_read_b64_tr_b16 a[60:61], v25 offset:36864
    ds_read_b64_tr_b16 a[62:63], v25 offset:37376
    v_mfma_f32_16x16x32_bf16 v[56:59], a[24:27], a[64:67], 0
    v_mfma_f32_16x16x32_bf16 v[60:63], a[28:31], a[64:67], 0
    s_cmp_lt_u32 s59, 4
    s_cbranch_scc0 L_recurrent_scan__spectral_fnet__mixer_gmlp__prompt_cb_3_1
    v_mfma_f32_16x16x32_bf16 v[64:67], a[0:3], v[76:79], 0
    s_branch L_recurrent_scan__spectral_fnet__mixer_gmlp__prompt_cb_3_d
L_recurrent_scan__spectral_fnet__mixer_gmlp__prompt_cb_3_1:
    s_nop 4
    v_mfma_f32_16x16x32_bf16 v[64:67], a[16:19], v[76:79], 0
L_recurrent_scan__spectral_fnet__mixer_gmlp__prompt_cb_3_d:
    s_waitcnt lgkmcnt(0)
    s_waitcnt vmcnt(9)
    s_barrier
    ds_read_b128 a[72:75], v18 offset:16384
    ds_read_b128 a[76:79], v19 offset:16384
    v_mfma_f32_16x16x32_bf16 v[32:35], a[32:35], a[68:71], v[32:35]
    ds_read_b64_tr_b16 a[0:1], v22 offset:8192
    ds_read_b64_tr_b16 a[2:3], v22 offset:8704
    v_mfma_f32_16x16x32_bf16 v[36:39], a[36:39], a[68:71], v[36:39]
    ds_read_b64_tr_b16 a[4:5], v23 offset:8192
    ds_read_b64_tr_b16 a[6:7], v23 offset:8704
    v_mfma_f32_16x16x32_bf16 v[40:43], a[40:43], a[68:71], v[40:43]
    ds_read_b64_tr_b16 a[8:9], v24 offset:8192
    s_cmp_lt_u32 s59, 4
    s_cbranch_scc0 L_recurrent_scan__spectral_fnet__mixer_gmlp__prompt_st_4
    s_add_u32 m0, s86, 0
    s_nop 0
    buffer_load_dwordx4 v16, s[8:11], s68 offen offset:0 lds
    buffer_load_dwordx4 v17, s[8:11], s68 offen offset:1024 lds
    s_add_u32 s68, s68, 128
    s_add_u32 m0, s84, 65536
    s_nop 0
    buffer_load_dwordx4 v20, s[12:15], s70 offen lds
    s_add_u32 s70, s70, s72
    s_add_u32 m0, s84, 98304
    s_nop 0
    buffer_load_dwordx4 v21, s[44:47], s71 offen lds
    s_add_u32 s71, s71, s73
L_recurrent_scan__spectral_fnet__mixer_gmlp__prompt_st_4:
    ds_read_b64_tr_b16 a[10:11], v24 offset:8704
    v_mfma_f32_16x16x32_bf16 v[68:71], v[76:79], a[68:71], v[68:71]
    ds_read_b64_tr_b16 a[12:13], v25 offset:8192
    ds_read_b64_tr_b16 a[14:15], v25 offset:8704
    v_mfma_f32_16x16x32_bf16 v[44:47], a[44:47], a[68:71], v[44:47]
    ds_read_b64_tr_b16 a[16:17], v22 offset:40960
    ds_read_b64_tr_b16 a[18:19], v22 offset:41472
    v_mfma_f32_16x16x32_bf16 v[48:51], a[48:51], a[68:71], v[48:51]
    ds_read_b64_tr_b16 a[20:21], v23 offset:40960
    ds_read_b64_tr_b16 a[22:23], v23 offset:41472
    v_mfma_f32_16x16x32_bf16 v[52:55], a[52:55], a[68:71], v[52:55]
    ds_read_b64_tr_b16 a[24:25], v24 offset:40960
    ds_read_b64_tr_b16 a[26:27], v24 offset:41472
    v_mfma_f32_16x16x32_bf16 v[72:75], a[68:71], a[68:71], v[72:75]
    ds_read_b64_tr_b16 a[28:29], v25 offset:40960
    ds_read_b64_tr_b16 a[30:31], v25 offset:41472
    v_mfma_f32_16x16x32_bf16 v[56:59], a[56:59], a[68:71], v[56:59]
    v_mfma_f32_16x16x32_bf16 v[60:63], a[60:63], a[68:71], v[60:63]
    s_cmp_lt_u32 s59, 4
    s_cbranch_scc0 L_recurrent_scan__spectral_fnet__mixer_gmlp__prompt_cb_5_1
    v_mfma_f32_16x16x32_bf16 v[64:67], a[32:35], v[76:79], v[64:67]
    s_branch L_recurrent_scan__spectral_fnet__mixer_gmlp__prompt_cb_5_d
L_recurrent_scan__spectral_fnet__mixer_gmlp__prompt_cb_5_1:
    v_mfma_f32_16x16x32_bf16 v[64:67], a[48:51], v[76:79], v[64:67]
L_recurrent_scan__spectral_fnet__mixer_gmlp__prompt_cb_5_d:
    s_waitcnt lgkmcnt(0)
    v_mfma_f32_16x16x32_bf16 v[32:35], a[0:3], a[72:75], v[32:35]
    ds_read_b64_tr_b16 a[32:33], v22 offset:12288
    ds_read_b64_tr_b16 a[34:35], v22 offset:12800
    v_mfma_f32_16x16x32_bf16 v[36:39], a[4:7], a[72:75], v[36:39]
    ds_read_b64_tr_b16 a[36:37], v23 offset:12288
    ds_read_b64_tr_b16 a[38:39], v23 offset:12800
    v_mfma_f32_16x16x32_bf16 v[40:43], a[8:11], a[72:75], v[40:43]
    ds_read_b64_tr_b16 a[40:41], v24 offset:12288
    s_cmp_lt_u32 s59, 4
    s_cbranch_scc1 L_recurrent_scan__spectral_fnet__mixer_gmlp__prompt_st_6
    s_add_u32 m0, s86, 0
    s_nop 0
    buffer_load_dwordx4 v16, s[8:11], s68 offen offset:0 lds
    buffer_load_dwordx4 v17, s[8:11], s68 offen offset:1024 lds
    s_add_u32 s68, s68, 128
    s_add_u32 m0, s84, 65536
    s_nop 0
    buffer_load_dwordx4 v20, s[12:15], s70 offen lds
    s_add_u32 s70, s70, s72
    s_add_u32 m0, s84, 98304
    s_nop 0
    buffer_load_dwordx4 v21, s[44:47], s71 offen lds
    s_add_u32 s71, s71, s73
L_recurrent_scan__spectral_fnet__mixer_gmlp__prompt_st_6:
    ds_read_b64_tr_b16 a[42:43], v24 offset:12800
    v_mfma_f32_16x16x32_bf16 v[68:71], v[76:79], a[72:75], v[68:71]
    ds_read_b64_tr_b16 a[44:45], v25 offset:12288
    ds_read_b64_tr_b16 a[46:47], v25 offset:12800
    v_mfma_f32_16x16x32_bf16 v[44:47], a[12:15], a[72:75], v[44:47]
    ds_read_b64_tr_b16 a[48:49], v22 offset:45056
    ds_read_b64_tr_b16 a[50:51], v22 offset:45568
    v_mfma_f32_16x16x32_bf16 v[48:51], a[16:19], a[72:75], v[48:51]
    ds_read_b64_tr_b16 a[52:53], v23 offset:45056
    ds_read_b64_tr_b16 a[54:55], v23 offset:45568
    v_mfma_f32_16x16x32_bf16 v[52:55], a[20:23], a[72:75], v[52:55]
    ds_read_b64_tr_b16 a[56:57], v24 offset:45056
    ds_read_b64_tr_b16 a[58:59], v24 offset:45568
    v_mfma_f32_16x16x32_bf16 v[72:75], a[72:75], a[72:75], v[72:75]
    ds_read_b64_tr_b16 a[60:61], v25 offset:45056
    ds_read_b64_tr_b16 a[62:63], v25 offset:45568
    v_mfma_f32_16x16x32_bf16 v[56:59], a[24:27], a[72:75], v[56:59]
    v_mfma_f32_16x16x32_bf16 v[60:63], a[28:31], a[72:75], v[60:63]
    s_cmp_lt_u32 s59, 4
    s_cbranch_scc0 L_recurrent_scan__spectral_fnet__mixer_gmlp__prompt_cb_7_1
    v_mfma_f32_16x16x32_bf16 v[64:67], a[0:3], v[76:79], v[64:67]
    s_branch L_recurrent_scan__spectral_fnet__mixer_gmlp__prompt_cb_7_d
L_recurrent_scan__spectral_fnet__mixer_gmlp__prompt_cb_7_1:
    v_mfma_f32_16x16x32_bf16 v[64:67], a[16:19], v[76:79], v[64:67]
L_recurrent_scan__spectral_fnet__mixer_gmlp__prompt_cb_7_d:
    s_waitcnt lgkmcnt(0)
    s_waitcnt vmcnt(9)
    s_barrier
    ds_read_b128 a[64:67], v18 offset:32768
    ds_read_b128 a[68:71], v19 offset:32768
    v_mfma_f32_16x16x32_bf16 v[32:35], a[32:35], a[76:79], v[32:35]
    ds_read_b64_tr_b16 a[0:1], v22 offset:16384
    ds_read_b64_tr_b16 a[2:3], v22 offset:16896
    v_mfma_f32_16x16x32_bf16 v[36:39], a[36:39], a[76:79], v[36:39]
    ds_read_b64_tr_b16 a[4:5], v23 offset:16384
    ds_read_b64_tr_b16 a[6:7], v23 offset:16896
    v_mfma_f32_16x16x32_bf16 v[40:43], a[40:43], a[76:79], v[40:43]
    ds_read_b64_tr_b16 a[8:9], v24 offset:16384
    s_cmp_lt_u32 s59, 4
    s_cbranch_scc0 L_recurrent_scan__spectral_fnet__mixer_gmlp__prompt_st_8
    s_add_u32 m0, s86, 16384
    s_nop 0
    buffer_load_dwordx4 v16, s[8:11], s68 offen offset:0 lds
    buffer_load_dwordx4 v17, s[8:11], s68 offen offset:1024 lds
    s_add_u32 s68, s68, 128
    s_add_u32 m0, s84, 73728
    s_nop 0
    buffer_load_dwordx4 v20, s[12:15], s70 offen lds
    s_add_u32 s70, s70, s72
    s_add_u32 m0, s84, 106496
    s_nop 0
    buffer_load_dwordx4 v21, s[44:47], s71 offen lds
    s_add_u32 s71, s71, s73
L_recurrent_scan__spectral_fnet__mixer_gmlp__prompt_st_8:
    ds_read_b64_tr_b16 a[10:11], v24 offset:16896
    v_mfma_f32_16x16x32_bf16 v[68:71], v[76:79], a[76:79], v[68:71]
    ds_read_b64_tr_b16 a[12:13], v25 offset:16384
    ds_read_b64_tr_b16 a[14:15], v25 offset:16896
    v_mfma_f32_16x16x32_bf16 v[44:47], a[44:47], a[76:79], v[44:47]
    ds_read_b64_tr_b16 a[16:17], v22 offset:49152
    ds_read_b64_tr_b16 a[18:19], v22 offset:49664
    v_mfma_f32_16x16x32_bf16 v[48:51], a[48:51], a[76:79], v[48:51]
    ds_read_b64_tr_b16 a[20:21], v23 offset:49152
    ds_read_b64_tr_b16 a[22:23], v23 offset:49664
    v_mfma_f32_16x16x32_bf16 v[52:55], a[52:55], a[76:79], v[52:55]
    ds_read_b64_tr_b16 a[24:25], v24 offset:49152
    ds_read_b64_tr_b16 a[26:27], v24 offset:49664
    v_mfma_f32_16x16x32_bf16 v[72:75], a[76:79], a[76:79], v[72:75]
    ds_read_b64_tr_b16 a[28:29], v25 offset:49152
    ds_read_b64_tr_b16 a[30:31], v25 offset:49664
    v_mfma_f32_16x16x32_bf16 v[56:59], a[56:59], a[76:79], v[56:59]
    v_mfma_f32_16x16x32_bf16 v[60:63], a[60:63], a[76:79], v[60:63]
    s_cmp_lt_u32 s59, 4
    s_cbranch_scc0 L_recurrent_scan__spectral_fnet__mixer_gmlp__prompt_cb_9_1
    v_mfma_f32_16x16x32_bf16 v[64:67], a[32:35], v[76:79], v[64:67]
    s_branch L_recurrent_scan__spectral_fnet__mixer_gmlp__prompt_cb_9_d
L_recurrent_scan__spectral_fnet__mixer_gmlp__prompt_cb_9_1:
    v_mfma_f32_16x16x32_bf16 v[64:67], a[48:51], v[76:79], v[64:67]
L_recurrent_scan__spectral_fnet__mixer_gmlp__prompt_cb_9_d:
    s_waitcnt lgkmcnt(0)
    v_mfma_f32_16x16x32_bf16 v[32:35], a[0:3], a[64:67], v[32:35]
    ds_read_b64_tr_b16 a[32:33], v22 offset:20480
    ds_read_b64_tr_b16 a[34:35], v22 offset:20992
    v_mfma_f32_16x16x32_bf16 v[36:39], a[4:7], a[64:67], v[36:39]
    ds_read_b64_tr_b16 a[36:37], v23 offset:20480
    ds_read_b64_tr_b16 a[38:39], v23 offset:20992
    v_mfma_f32_16x16x32_bf16 v[40:43], a[8:11], a[64:67], v[40:43]
    ds_read_b64_tr_b16 a[40:41], v24 offset:20480
    s_cmp_lt_u32 s59, 4
    s_cbranch_scc1 L_recurrent_scan__spectral_fnet__mixer_gmlp__prompt_st_10
    s_add_u32 m0, s86, 16384
    s_nop 0
    buffer_load_dwordx4 v16, s[8:11], s68 offen offset:0 lds
    buffer_load_dwordx4 v17, s[8:11], s68 offen offset:1024 lds
    s_add_u32 s68, s68, 128
    s_add_u32 m0, s84, 73728
    s_nop 0
    buffer_load_dwordx4 v20, s[12:15], s70 offen lds
    s_add_u32 s70, s70, s72
    s_add_u32 m0, s84, 106496
    s_nop 0
    buffer_load_dwordx4 v21, s[44:47], s71 offen lds
    s_add_u32 s71, s71, s73
L_recurrent_scan__spectral_fnet__mixer_gmlp__prompt_st_10:
    ds_read_b64_tr_b16 a[42:43], v24 offset:20992
    v_mfma_f32_16x16x32_bf16 v[68:71], v[76:79], a[64:67], v[68:71]
    ds_read_b64_tr_b16 a[44:45], v25 offset:20480
    ds_read_b64_tr_b16 a[46:47], v25 offset:20992
    v_mfma_f32_16x16x32_bf16 v[44:47], a[12:15], a[64:67], v[44:47]
    ds_read_b64_tr_b16 a[48:49], v22 offset:53248
    ds_read_b64_tr_b16 a[50:51], v22 offset:53760
    v_mfma_f32_16x16x32_bf16 v[48:51], a[16:19], a[64:67], v[48:51]
    ds_read_b64_tr_b16 a[52:53], v23 offset:53248
    ds_read_b64_tr_b16 a[54:55], v23 offset:53760
    v_mfma_f32_16x16x32_bf16 v[52:55], a[20:23], a[64:67], v[52:55]
    ds_read_b64_tr_b16 a[56:57], v24 offset:53248
    ds_read_b64_tr_b16 a[58:59], v24 offset:53760
    v_mfma_f32_16x16x32_bf16 v[72:75], a[64:67], a[64:67], v[72:75]
    ds_read_b64_tr_b16 a[60:61], v25 offset:53248
    ds_read_b64_tr_b16 a[62:63], v25 offset:53760
    v_mfma_f32_16x16x32_bf16 v[56:59], a[24:27], a[64:67], v[56:59]
    v_mfma_f32_16x16x32_bf16 v[60:63], a[28:31], a[64:67], v[60:63]
    s_cmp_lt_u32 s59, 4
    s_cbranch_scc0 L_recurrent_scan__spectral_fnet__mixer_gmlp__prompt_cb_11_1
    v_mfma_f32_16x16x32_bf16 v[64:67], a[0:3], v[76:79], v[64:67]
    s_branch L_recurrent_scan__spectral_fnet__mixer_gmlp__prompt_cb_11_d
L_recurrent_scan__spectral_fnet__mixer_gmlp__prompt_cb_11_1:
    v_mfma_f32_16x16x32_bf16 v[64:67], a[16:19], v[76:79], v[64:67]
L_recurrent_scan__spectral_fnet__mixer_gmlp__prompt_cb_11_d:
    s_waitcnt lgkmcnt(0)
    s_waitcnt vmcnt(8)
    s_barrier
    v_readfirstlane_b32 s58, v127
    s_add_u32 s58, s58, 1
    ds_read_b128 a[72:75], v18 offset:49152
    ds_read_b128 a[76:79], v19 offset:49152
    v_mfma_f32_16x16x32_bf16 v[32:35], a[32:35], a[68:71], v[32:35]
    ds_read_b64_tr_b16 a[0:1], v22 offset:24576
    ds_read_b64_tr_b16 a[2:3], v22 offset:25088
    v_mfma_f32_16x16x32_bf16 v[36:39], a[36:39], a[68:71], v[36:39]
    ds_read_b64_tr_b16 a[4:5], v23 offset:24576
    ds_read_b64_tr_b16 a[6:7], v23 offset:25088
    v_mfma_f32_16x16x32_bf16 v[40:43], a[40:43], a[68:71], v[40:43]
    ds_read_b64_tr_b16 a[8:9], v24 offset:24576
    s_cmp_lt_u32 s59, 4
    s_cbranch_scc0 L_recurrent_scan__spectral_fnet__mixer_gmlp__prompt_st_12
    s_add_u32 m0, s86, 32768
    s_nop 0
    buffer_load_dwordx4 v16, s[8:11], s68 offen offset:0 lds
    buffer_load_dwordx4 v17, s[8:11], s68 offen offset:1024 lds
    s_add_u32 s68, s68, 128
    s_add_u32 m0, s84, 81920
    s_nop 0
    buffer_load_dwordx4 v20, s[12:15], s70 offen lds
    s_add_u32 s70, s70, s72
    s_add_u32 m0, s84, 114688
    s_nop 0
    buffer_load_dwordx4 v21, s[44:47], s71 offen lds
    s_add_u32 s71, s71, s73
L_recurrent_scan__spectral_fnet__mixer_gmlp__prompt_st_12:
    ds_read_b64_tr_b16 a[10:11], v24 offset:25088
    v_mfma_f32_16x16x32_bf16 v[68:71], v[76:79], a[68:71], v[68:71]
    ds_read_b64_tr_b16 a[12:13], v25 offset:24576
    ds_read_b64_tr_b16 a[14:15], v25 offset:25088
    v_mfma_f32_16x16x32_bf16 v[44:47], a[44:47], a[68:71], v[44:47]
    ds_read_b64_tr_b16 a[16:17], v22 offset:57344
    ds_read_b64_tr_b16 a[18:19], v22 offset:57856
    v_mfma_f32_16x16x32_bf16 v[48:51], a[48:51], a[68:71], v[48:51]
    ds_read_b64_tr_b16 a[20:21], v23 offset:57344
    ds_read_b64_tr_b16 a[22:23], v23 offset:57856
    v_mfma_f32_16x16x32_bf16 v[52:55], a[52:55], a[68:71], v[52:55]
    ds_read_b64_tr_b16 a[24:25], v24 offset:57344
    ds_read_b64_tr_b16 a[26:27], v24 offset:57856
    v_mfma_f32_16x16x32_bf16 v[72:75], a[68:71], a[68:71], v[72:75]
    ds_read_b64_tr_b16 a[28:29], v25 offset:57344
    ds_read_b64_tr_b16 a[30:31], v25 offset:57856
    v_mfma_f32_16x16x32_bf16 v[56:59], a[56:59], a[68:71], v[56:59]
    v_mfma_f32_16x16x32_bf16 v[60:63], a[60:63], a[68:71], v[60:63]
    s_cmp_lt_u32 s59, 4
    s_cbranch_scc0 L_recurrent_scan__spectral_fnet__mixer_gmlp__prompt_cb_13_1
    v_mfma_f32_16x16x32_bf16 v[64:67], a[32:35], v[76:79], v[64:67]
    s_branch L_recurrent_scan__spectral_fnet__mixer_gmlp__prompt_cb_13_d
L_recurrent_scan__spectral_fnet__mixer_gmlp__prompt_cb_13_1:
    v_mfma_f32_16x16x32_bf16 v[64:67], a[48:51], v[76:79], v[64:67]
L_recurrent_scan__spectral_fnet__mixer_gmlp__prompt_cb_13_d:
    s_waitcnt lgkmcnt(0)
    v_mfma_f32_16x16x32_bf16 v[32:35], a[0:3], a[72:75], v[32:35]
    ds_read_b64_tr_b16 a[32:33], v22 offset:28672
    ds_read_b64_tr_b16 a[34:35], v22 offset:29184
    v_mfma_f32_16x16x32_bf16 v[36:39], a[4:7], a[72:75], v[36:39]
    ds_read_b64_tr_b16 a[36:37], v23 offset:28672
    ds_read_b64_tr_b16 a[38:39], v23 offset:29184
    v_mfma_f32_16x16x32_bf16 v[40:43], a[8:11], a[72:75], v[40:43]
    ds_read_b64_tr_b16 a[40:41], v24 offset:28672
    s_cmp_lt_u32 s59, 4
    s_cbranch_scc1 L_recurrent_scan__spectral_fnet__mixer_gmlp__prompt_st_14
    s_add_u32 m0, s86, 32768
    s_nop 0
    buffer_load_dwordx4 v16, s[8:11], s68 offen offset:0 lds
    buffer_load_dwordx4 v17, s[8:11], s68 offen offset:1024 lds
    s_add_u32 s68, s68, 128
    s_add_u32 m0, s84, 81920
    s_nop 0
    buffer_load_dwordx4 v20, s[12:15], s70 offen lds
    s_add_u32 s70, s70, s72
    s_add_u32 m0, s84, 114688
    s_nop 0
    buffer_load_dwordx4 v21, s[44:47], s71 offen lds
    s_add_u32 s71, s71, s73
L_recurrent_scan__spectral_fnet__mixer_gmlp__prompt_st_14:
    ds_read_b64_tr_b16 a[42:43], v24 offset:29184
    v_mfma_f32_16x16x32_bf16 v[68:71], v[76:79], a[72:75], v[68:71]
    ds_read_b64_tr_b16 a[44:45], v25 offset:28672
    ds_read_b64_tr_b16 a[46:47], v25 offset:29184
    v_mfma_f32_16x16x32_bf16 v[44:47], a[12:15], a[72:75], v[44:47]
    ds_read_b64_tr_b16 a[48:49], v22 offset:61440
    ds_read_b64_tr_b16 a[50:51], v22 offset:61952
    v_mfma_f32_16x16x32_bf16 v[48:51], a[16:19], a[72:75], v[48:51]
    ds_read_b64_tr_b16 a[52:53], v23 offset:61440
    ds_read_b64_tr_b16 a[54:55], v23 offset:61952
    v_mfma_f32_16x16x32_bf16 v[52:55], a[20:23], a[72:75], v[52:55]
    ds_read_b64_tr_b16 a[56:57], v24 offset:61440
    ds_read_b64_tr_b16 a[58:59], v24 offset:61952
    v_mfma_f32_16x16x32_bf16 v[72:75], a[72:75], a[72:75], v[72:75]
    ds_read_b64_tr_b16 a[60:61], v25 offset:61440
    ds_read_b64_tr_b16 a[62:63], v25 offset:61952
    v_mfma_f32_16x16x32_bf16 v[56:59], a[24:27], a[72:75], v[56:59]
    v_mfma_f32_16x16x32_bf16 v[60:63], a[28:31], a[72:75], v[60:63]
    s_cmp_lt_u32 s59, 4
    s_cbranch_scc0 L_recurrent_scan__spectral_fnet__mixer_gmlp__prompt_cb_15_1
    v_mfma_f32_16x16x32_bf16 v[64:67], a[0:3], v[76:79], v[64:67]
    s_branch L_recurrent_scan__spectral_fnet__mixer_gmlp__prompt_cb_15_d
L_recurrent_scan__spectral_fnet__mixer_gmlp__prompt_cb_15_1:
    v_mfma_f32_16x16x32_bf16 v[64:67], a[16:19], v[76:79], v[64:67]
L_recurrent_scan__spectral_fnet__mixer_gmlp__prompt_cb_15_d:
    s_waitcnt lgkmcnt(0)
    s_waitcnt vmcnt(8)
    s_barrier
    ds_read_b128 a[64:67], v18 offset:0
    ds_read_b128 a[68:71], v19 offset:0
    v_mfma_f32_16x16x32_bf16 v[32:35], a[32:35], a[76:79], v[32:35]
    ds_read_b64_tr_b16 a[0:1], v22 offset:0
    ds_read_b64_tr_b16 a[2:3], v22 offset:512
    v_mfma_f32_16x16x32_bf16 v[36:39], a[36:39], a[76:79], v[36:39]
    ds_read_b64_tr_b16 a[4:5], v23 offset:0
    ds_read_b64_tr_b16 a[6:7], v23 offset:512
    v_mfma_f32_16x16x32_bf16 v[40:43], a[40:43], a[76:79], v[40:43]
    ds_read_b64_tr_b16 a[8:9], v24 offset:0
    s_cmp_lt_u32 s59, 4
    s_cbranch_scc0 L_recurrent_scan__spectral_fnet__mixer_gmlp__prompt_st_16
    s_add_u32 m0, s86, 49152
    s_nop 0
    buffer_load_dwordx4 v16, s[8:11], s68 offen offset:0 lds
    buffer_load_dwordx4 v17, s[8:11], s68 offen offset:1024 lds
    s_add_u32 s68, s68, 128
    s_add_u32 m0, s84, 90112
    s_nop 0
    buffer_load_dwordx4 v20, s[12:15], s70 offen lds
    s_add_u32 s70, s70, s72
    s_add_u32 m0, s84, 122880
    s_nop 0
    buffer_load_dwordx4 v21, s[44:47], s71 offen lds
    s_add_u32 s71, s71, s73
    s_lshl_b32 s4, s62, 18
    s_lshl_b32 s5, s63, 15
    s_add_u32 s4, s4, s5
    s_lshl_b32 s5, s59, 12
    s_add_u32 s4, s4, s5
    v_and_b32 v10, 31, v1
    v_lshlrev_b32 v10, 7, v10
    buffer_load_dword v126, v10, s[24:27], s4 offen
L_recurrent_scan__spectral_fnet__mixer_gmlp__prompt_st_16:
    ds_read_b64_tr_b16 a[10:11], v24 offset:512
    v_mfma_f32_16x16x32_bf16 v[68:71], v[76:79], a[76:79], v[68:71]
    ds_read_b64_tr_b16 a[12:13], v25 offset:0
    ds_read_b64_tr_b16 a[14:15], v25 offset:512
    v_mfma_f32_16x16x32_bf16 v[44:47], a[44:47], a[76:79], v[44:47]
    ds_read_b64_tr_b16 a[16:17], v22 offset:32768
    ds_read_b64_tr_b16 a[18:19], v22 offset:33280
    v_mfma_f32_16x16x32_bf16 v[48:51], a[48:51], a[76:79], v[48:51]
    ds_read_b64_tr_b16 a[20:21], v23 offset:32768
    ds_read_b64_tr_b16 a[22:23], v23 offset:33280
    v_mfma_f32_16x16x32_bf16 v[52:55], a[52:55], a[76:79], v[52:55]
    ds_read_b64_tr_b16 a[24:25], v24 offset:32768
    ds_read_b64_tr_b16 a[26:27], v24 offset:33280
    v_mfma_f32_16x16x32_bf16 v[72:75], a[76:79], a[76:79], v[72:75]
    ds_read_b64_tr_b16 a[28:29], v25 offset:32768
    ds_read_b64_tr_b16 a[30:31], v25 offset:33280
    v_mfma_f32_16x16x32_bf16 v[56:59], a[56:59], a[76:79], v[56:59]
    v_mfma_f32_16x16x32_bf16 v[60:63], a[60:63], a[76:79], v[60:63]
    s_cmp_lt_u32 s59, 4
    s_cbranch_scc0 L_recurrent_scan__spectral_fnet__mixer_gmlp__prompt_cb_17_1
    v_mfma_f32_16x16x32_bf16 v[64:67], a[32:35], v[76:79], v[64:67]
    s_branch L_recurrent_scan__spectral_fnet__mixer_gmlp__prompt_cb_17_d
L_recurrent_scan__spectral_fnet__mixer_gmlp__prompt_cb_17_1:
    v_mfma_f32_16x16x32_bf16 v[64:67], a[48:51], v[76:79], v[64:67]
L_recurrent_scan__spectral_fnet__mixer_gmlp__prompt_cb_17_d:
    s_waitcnt lgkmcnt(0)
    v_mfma_f32_16x16x32_bf16 v[32:35], a[0:3], a[64:67], v[32:35]
    ds_read_b64_tr_b16 a[32:33], v22 offset:4096
    ds_read_b64_tr_b16 a[34:35], v22 offset:4608
    v_mfma_f32_16x16x32_bf16 v[36:39], a[4:7], a[64:67], v[36:39]
    ds_read_b64_tr_b16 a[36:37], v23 offset:4096
    ds_read_b64_tr_b16 a[38:39], v23 offset:4608
    v_mfma_f32_16x16x32_bf16 v[40:43], a[8:11], a[64:67], v[40:43]
    ds_read_b64_tr_b16 a[40:41], v24 offset:4096
    s_cmp_lt_u32 s59, 4
    s_cbranch_scc1 L_recurrent_scan__spectral_fnet__mixer_gmlp__prompt_st_18
    s_add_u32 m0, s86, 49152
    s_nop 0
    buffer_load_dwordx4 v16, s[8:11], s68 offen offset:0 lds
    buffer_load_dwordx4 v17, s[8:11], s68 offen offset:1024 lds
    s_add_u32 s68, s68, 128
    s_add_u32 m0, s84, 90112
    s_nop 0
    buffer_load_dwordx4 v20, s[12:15], s70 offen lds
    s_add_u32 s70, s70, s72
    s_add_u32 m0, s84, 122880
    s_nop 0
    buffer_load_dwordx4 v21, s[44:47], s71 offen lds
    s_add_u32 s71, s71, s73
    s_lshl_b32 s4, s62, 18
    s_lshl_b32 s5, s63, 15
    s_add_u32 s4, s4, s5
    s_lshl_b32 s5, s59, 12
    s_add_u32 s4, s4, s5
    v_and_b32 v10, 31, v1
    v_lshlrev_b32 v10, 7, v10
    buffer_load_dword v126, v10, s[24:27], s4 offen
L_recurrent_scan__spectral_fnet__mixer_gmlp__prompt_st_18:
    ds_read_b64_tr_b16 a[42:43], v24 offset:4608
    v_mfma_f32_16x16x32_bf16 v[68:71], v[76:79], a[64:67], v[68:71]
    ds_read_b64_tr_b16 a[44:45], v25 offset:4096
    ds_read_b64_tr_b16 a[46:47], v25 offset:4608
    v_mfma_f32_16x16x32_bf16 v[44:47], a[12:15], a[64:67], v[44:47]
    ds_read_b64_tr_b16 a[48:49], v22 offset:36864
    ds_read_b64_tr_b16 a[50:51], v22 offset:37376
    v_mfma_f32_16x16x32_bf16 v[48:51], a[16:19], a[64:67], v[48:51]
    ds_read_b64_tr_b16 a[52:53], v23 offset:36864
    ds_read_b64_tr_b16 a[54:55], v23 offset:37376
    v_mfma_f32_16x16x32_bf16 v[52:55], a[20:23], a[64:67], v[52:55]
    ds_read_b64_tr_b16 a[56:57], v24 offset:36864
    ds_read_b64_tr_b16 a[58:59], v24 offset:37376
    v_mfma_f32_16x16x32_bf16 v[72:75], a[64:67], a[64:67], v[72:75]
    ds_read_b64_tr_b16 a[60:61], v25 offset:36864
    ds_read_b64_tr_b16 a[62:63], v25 offset:37376
    v_mfma_f32_16x16x32_bf16 v[56:59], a[24:27], a[64:67], v[56:59]
    v_mfma_f32_16x16x32_bf16 v[60:63], a[28:31], a[64:67], v[60:63]
    s_cmp_lt_u32 s59, 4
    s_cbranch_scc0 L_recurrent_scan__spectral_fnet__mixer_gmlp__prompt_cb_19_1
    v_mfma_f32_16x16x32_bf16 v[64:67], a[0:3], v[76:79], v[64:67]
    s_branch L_recurrent_scan__spectral_fnet__mixer_gmlp__prompt_cb_19_d
L_recurrent_scan__spectral_fnet__mixer_gmlp__prompt_cb_19_1:
    v_mfma_f32_16x16x32_bf16 v[64:67], a[16:19], v[76:79], v[64:67]
L_recurrent_scan__spectral_fnet__mixer_gmlp__prompt_cb_19_d:
    s_waitcnt lgkmcnt(0)
    s_waitcnt vmcnt(9)
    s_barrier
    ds_read_b128 a[72:75], v18 offset:16384
    ds_read_b128 a[76:79], v19 offset:16384
    v_mfma_f32_16x16x32_bf16 v[32:35], a[32:35], a[68:71], v[32:35]
    ds_read_b64_tr_b16 a[0:1], v22 offset:8192
    ds_read_b64_tr_b16 a[2:3], v22 offset:8704
    v_mfma_f32_16x16x32_bf16 v[36:39], a[36:39], a[68:71], v[36:39]
    ds_read_b64_tr_b16 a[4:5], v23 offset:8192
    ds_read_b64_tr_b16 a[6:7], v23 offset:8704
    v_mfma_f32_16x16x32_bf16 v[40:43], a[40:43], a[68:71], v[40:43]
    ds_read_b64_tr_b16 a[8:9], v24 offset:8192
    ds_read_b64_tr_b16 a[10:11], v24 offset:8704
    v_mfma_f32_16x16x32_bf16 v[68:71], v[76:79], a[68:71], v[68:71]
    ds_read_b64_tr_b16 a[12:13], v25 offset:8192
    ds_read_b64_tr_b16 a[14:15], v25 offset:8704
    v_mfma_f32_16x16x32_bf16 v[44:47], a[44:47], a[68:71], v[44:47]
    ds_read_b64_tr_b16 a[16:17], v22 offset:40960
    ds_read_b64_tr_b16 a[18:19], v22 offset:41472
    v_mfma_f32_16x16x32_bf16 v[48:51], a[48:51], a[68:71], v[48:51]
    ds_read_b64_tr_b16 a[20:21], v23 offset:40960
    ds_read_b64_tr_b16 a[22:23], v23 offset:41472
    v_mfma_f32_16x16x32_bf16 v[52:55], a[52:55], a[68:71], v[52:55]
    ds_read_b64_tr_b16 a[24:25], v24 offset:40960
    ds_read_b64_tr_b16 a[26:27], v24 offset:41472
    v_mfma_f32_16x16x32_bf16 v[72:75], a[68:71], a[68:71], v[72:75]
    ds_read_b64_tr_b16 a[28:29], v25 offset:40960
    ds_read_b64_tr_b16 a[30:31], v25 offset:41472
    v_mfma_f32_16x16x32_bf16 v[56:59], a[56:59], a[68:71], v[56:59]
    v_mfma_f32_16x16x32_bf16 v[60:63], a[60:63], a[68:71], v[60:63]
    s_cmp_lt_u32 s59, 4
    s_cbranch_scc0 L_recurrent_scan__spectral_fnet__mixer_gmlp__prompt_cb_20_1
    v_mfma_f32_16x16x32_bf16 v[64:67], a[32:35], v[76:79], v[64:67]
    s_branch L_recurrent_scan__spectral_fnet__mixer_gmlp__prompt_cb_20_d
L_recurrent_scan__spectral_fnet__mixer_gmlp__prompt_cb_20_1:
    v_mfma_f32_16x16x32_bf16 v[64:67], a[48:51], v[76:79], v[64:67]
L_recurrent_scan__spectral_fnet__mixer_gmlp__prompt_cb_20_d:
    s_waitcnt lgkmcnt(0)
    v_mfma_f32_16x16x32_bf16 v[32:35], a[0:3], a[72:75], v[32:35]
    ds_read_b64_tr_b16 a[32:33], v22 offset:12288
    ds_read_b64_tr_b16 a[34:35], v22 offset:12800
    v_mfma_f32_16x16x32_bf16 v[36:39], a[4:7], a[72:75], v[36:39]
    ds_read_b64_tr_b16 a[36:37], v23 offset:12288
    ds_read_b64_tr_b16 a[38:39], v23 offset:12800
    v_mfma_f32_16x16x32_bf16 v[40:43], a[8:11], a[72:75], v[40:43]
    ds_read_b64_tr_b16 a[40:41], v24 offset:12288
    ds_read_b64_tr_b16 a[42:43], v24 offset:12800
    v_mfma_f32_16x16x32_bf16 v[68:71], v[76:79], a[72:75], v[68:71]
    ds_read_b64_tr_b16 a[44:45], v25 offset:12288
    ds_read_b64_tr_b16 a[46:47], v25 offset:12800
    v_mfma_f32_16x16x32_bf16 v[44:47], a[12:15], a[72:75], v[44:47]
    ds_read_b64_tr_b16 a[48:49], v22 offset:45056
    ds_read_b64_tr_b16 a[50:51], v22 offset:45568
    v_mfma_f32_16x16x32_bf16 v[48:51], a[16:19], a[72:75], v[48:51]
    ds_read_b64_tr_b16 a[52:53], v23 offset:45056
    ds_read_b64_tr_b16 a[54:55], v23 offset:45568
    v_mfma_f32_16x16x32_bf16 v[52:55], a[20:23], a[72:75], v[52:55]
    ds_read_b64_tr_b16 a[56:57], v24 offset:45056
    ds_read_b64_tr_b16 a[58:59], v24 offset:45568
    v_mfma_f32_16x16x32_bf16 v[72:75], a[72:75], a[72:75], v[72:75]
    ds_read_b64_tr_b16 a[60:61], v25 offset:45056
    ds_read_b64_tr_b16 a[62:63], v25 offset:45568
    v_mfma_f32_16x16x32_bf16 v[56:59], a[24:27], a[72:75], v[56:59]
    v_mfma_f32_16x16x32_bf16 v[60:63], a[28:31], a[72:75], v[60:63]
    s_cmp_lt_u32 s59, 4
    s_cbranch_scc0 L_recurrent_scan__spectral_fnet__mixer_gmlp__prompt_cb_21_1
    v_mfma_f32_16x16x32_bf16 v[64:67], a[0:3], v[76:79], v[64:67]
    s_branch L_recurrent_scan__spectral_fnet__mixer_gmlp__prompt_cb_21_d
L_recurrent_scan__spectral_fnet__mixer_gmlp__prompt_cb_21_1:
    v_mfma_f32_16x16x32_bf16 v[64:67], a[16:19], v[76:79], v[64:67]
L_recurrent_scan__spectral_fnet__mixer_gmlp__prompt_cb_21_d:
    s_waitcnt lgkmcnt(0)
    s_mul_i32 s5, s82, 0
    s_add_u32 m0, s5, s79
    s_nop 0
    buffer_load_dwordx4 v6, s[24:27], s83 offen lds
    buffer_load_dwordx4 v7, s[24:27], s83 offen offset:1024 lds
    s_add_u32 s5, s83, 63488
    buffer_load_dwordx4 v6, s[24:27], s5 offen offset:2048 lds
    buffer_load_dwordx4 v7, s[24:27], s5 offen offset:3072 lds
    s_add_u32 s83, s83, 128
    s_waitcnt vmcnt(9)
    s_barrier
    ds_read_b128 a[64:67], v18 offset:32768
    ds_read_b128 a[68:71], v19 offset:32768
    v_mfma_f32_16x16x32_bf16 v[32:35], a[32:35], a[76:79], v[32:35]
    ds_read_b64_tr_b16 a[0:1], v22 offset:16384
    ds_read_b64_tr_b16 a[2:3], v22 offset:16896
    v_mfma_f32_16x16x32_bf16 v[36:39], a[36:39], a[76:79], v[36:39]
    ds_read_b64_tr_b16 a[4:5], v23 offset:16384
    ds_read_b64_tr_b16 a[6:7], v23 offset:16896
    v_mfma_f32_16x16x32_bf16 v[40:43], a[40:43], a[76:79], v[40:43]
    ds_read_b64_tr_b16 a[8:9], v24 offset:16384
    ds_read_b64_tr_b16 a[10:11], v24 offset:16896
    v_mfma_f32_16x16x32_bf16 v[68:71], v[76:79], a[76:79], v[68:71]
    ds_read_b64_tr_b16 a[12:13], v25 offset:16384
    ds_read_b64_tr_b16 a[14:15], v25 offset:16896
    v_mfma_f32_16x16x32_bf16 v[44:47], a[44:47], a[76:79], v[44:47]
    ds_read_b64_tr_b16 a[16:17], v22 offset:49152
    ds_read_b64_tr_b16 a[18:19], v22 offset:49664
    v_mfma_f32_16x16x32_bf16 v[48:51], a[48:51], a[76:79], v[48:51]
    ds_read_b64_tr_b16 a[20:21], v23 offset:49152
    ds_read_b64_tr_b16 a[22:23], v23 offset:49664
    v_mfma_f32_16x16x32_bf16 v[52:55], a[52:55], a[76:79], v[52:55]
    ds_read_b64_tr_b16 a[24:25], v24 offset:49152
    ds_read_b64_tr_b16 a[26:27], v24 offset:49664
    v_mfma_f32_16x16x32_bf16 v[72:75], a[76:79], a[76:79], v[72:75]
    ds_read_b64_tr_b16 a[28:29], v25 offset:49152
    ds_read_b64_tr_b16 a[30:31], v25 offset:49664
    v_mfma_f32_16x16x32_bf16 v[56:59], a[56:59], a[76:79], v[56:59]
    v_mfma_f32_16x16x32_bf16 v[60:63], a[60:63], a[76:79], v[60:63]
    s_cmp_lt_u32 s59, 4
    s_cbranch_scc0 L_recurrent_scan__spectral_fnet__mixer_gmlp__prompt_cb_22_1
    v_mfma_f32_16x16x32_bf16 v[64:67], a[32:35], v[76:79], v[64:67]
    s_branch L_recurrent_scan__spectral_fnet__mixer_gmlp__prompt_cb_22_d
L_recurrent_scan__spectral_fnet__mixer_gmlp__prompt_cb_22_1:
    v_mfma_f32_16x16x32_bf16 v[64:67], a[48:51], v[76:79], v[64:67]
L_recurrent_scan__spectral_fnet__mixer_gmlp__prompt_cb_22_d:
    s_waitcnt lgkmcnt(0)
    v_mfma_f32_16x16x32_bf16 v[32:35], a[0:3], a[64:67], v[32:35]
    ds_read_b64_tr_b16 a[32:33], v22 offset:20480
    ds_read_b64_tr_b16 a[34:35], v22 offset:20992
    v_mfma_f32_16x16x32_bf16 v[36:39], a[4:7], a[64:67], v[36:39]
    ds_read_b64_tr_b16 a[36:37], v23 offset:20480
    ds_read_b64_tr_b16 a[38:39], v23 offset:20992
    v_mfma_f32_16x16x32_bf16 v[40:43], a[8:11], a[64:67], v[40:43]
    ds_read_b64_tr_b16 a[40:41], v24 offset:20480
    ds_read_b64_tr_b16 a[42:43], v24 offset:20992
    v_mfma_f32_16x16x32_bf16 v[68:71], v[76:79], a[64:67], v[68:71]
    ds_read_b64_tr_b16 a[44:45], v25 offset:20480
    ds_read_b64_tr_b16 a[46:47], v25 offset:20992
    v_mfma_f32_16x16x32_bf16 v[44:47], a[12:15], a[64:67], v[44:47]
    ds_read_b64_tr_b16 a[48:49], v22 offset:53248
    ds_read_b64_tr_b16 a[50:51], v22 offset:53760
    v_mfma_f32_16x16x32_bf16 v[48:51], a[16:19], a[64:67], v[48:51]
    ds_read_b64_tr_b16 a[52:53], v23 offset:53248
    ds_read_b64_tr_b16 a[54:55], v23 offset:53760
    v_mfma_f32_16x16x32_bf16 v[52:55], a[20:23], a[64:67], v[52:55]
    ds_read_b64_tr_b16 a[56:57], v24 offset:53248
    ds_read_b64_tr_b16 a[58:59], v24 offset:53760
    v_mfma_f32_16x16x32_bf16 v[72:75], a[64:67], a[64:67], v[72:75]
    ds_read_b64_tr_b16 a[60:61], v25 offset:53248
    ds_read_b64_tr_b16 a[62:63], v25 offset:53760
    v_mfma_f32_16x16x32_bf16 v[56:59], a[24:27], a[64:67], v[56:59]
    v_mfma_f32_16x16x32_bf16 v[60:63], a[28:31], a[64:67], v[60:63]
    s_cmp_lt_u32 s59, 4
    s_cbranch_scc0 L_recurrent_scan__spectral_fnet__mixer_gmlp__prompt_cb_23_1
    v_mfma_f32_16x16x32_bf16 v[64:67], a[0:3], v[76:79], v[64:67]
    s_branch L_recurrent_scan__spectral_fnet__mixer_gmlp__prompt_cb_23_d
L_recurrent_scan__spectral_fnet__mixer_gmlp__prompt_cb_23_1:
    v_mfma_f32_16x16x32_bf16 v[64:67], a[16:19], v[76:79], v[64:67]
L_recurrent_scan__spectral_fnet__mixer_gmlp__prompt_cb_23_d:
    s_waitcnt lgkmcnt(0)
    s_mul_i32 s5, s82, 1
    s_add_u32 m0, s5, s79
    s_nop 0
    buffer_load_dwordx4 v6, s[24:27], s83 offen lds
    buffer_load_dwordx4 v7, s[24:27], s83 offen offset:1024 lds
    s_add_u32 s5, s83, 63488
    buffer_load_dwordx4 v6, s[24:27], s5 offen offset:2048 lds
    buffer_load_dwordx4 v7, s[24:27], s5 offen offset:3072 lds
    s_add_u32 s83, s83, 128
    s_waitcnt vmcnt(9)
    s_barrier
    ds_read_b128 a[72:75], v18 offset:49152
    ds_read_b128 a[76:79], v19 offset:49152
    v_mfma_f32_16x16x32_bf16 v[32:35], a[32:35], a[68:71], v[32:35]
    ds_read_b64_tr_b16 a[0:1], v22 offset:24576
    ds_read_b64_tr_b16 a[2:3], v22 offset:25088
    v_mfma_f32_16x16x32_bf16 v[36:39], a[36:39], a[68:71], v[36:39]
    ds_read_b64_tr_b16 a[4:5], v23 offset:24576
    ds_read_b64_tr_b16 a[6:7], v23 offset:25088
    v_mfma_f32_16x16x32_bf16 v[40:43], a[40:43], a[68:71], v[40:43]
    ds_read_b64_tr_b16 a[8:9], v24 offset:24576
    ds_read_b64_tr_b16 a[10:11], v24 offset:25088
    v_mfma_f32_16x16x32_bf16 v[68:71], v[76:79], a[68:71], v[68:71]
    ds_read_b64_tr_b16 a[12:13], v25 offset:24576
    ds_read_b64_tr_b16 a[14:15], v25 offset:25088
    v_mfma_f32_16x16x32_bf16 v[44:47], a[44:47], a[68:71], v[44:47]
    ds_read_b64_tr_b16 a[16:17], v22 offset:57344
    ds_read_b64_tr_b16 a[18:19], v22 offset:57856
    v_mfma_f32_16x16x32_bf16 v[48:51], a[48:51], a[68:71], v[48:51]
    ds_read_b64_tr_b16 a[20:21], v23 offset:57344
    ds_read_b64_tr_b16 a[22:23], v23 offset:57856
    v_mfma_f32_16x16x32_bf16 v[52:55], a[52:55], a[68:71], v[52:55]
    ds_read_b64_tr_b16 a[24:25], v24 offset:57344
    ds_read_b64_tr_b16 a[26:27], v24 offset:57856
    v_mfma_f32_16x16x32_bf16 v[72:75], a[68:71], a[68:71], v[72:75]
    ds_read_b64_tr_b16 a[28:29], v25 offset:57344
    ds_read_b64_tr_b16 a[30:31], v25 offset:57856
    v_mfma_f32_16x16x32_bf16 v[56:59], a[56:59], a[68:71], v[56:59]
    v_mfma_f32_16x16x32_bf16 v[60:63], a[60:63], a[68:71], v[60:63]
    s_cmp_lt_u32 s59, 4
    s_cbranch_scc0 L_recurrent_scan__spectral_fnet__mixer_gmlp__prompt_cb_24_1
    v_mfma_f32_16x16x32_bf16 v[64:67], a[32:35], v[76:79], v[64:67]
    s_branch L_recurrent_scan__spectral_fnet__mixer_gmlp__prompt_cb_24_d
L_recurrent_scan__spectral_fnet__mixer_gmlp__prompt_cb_24_1:
    v_mfma_f32_16x16x32_bf16 v[64:67], a[48:51], v[76:79], v[64:67]
L_recurrent_scan__spectral_fnet__mixer_gmlp__prompt_cb_24_d:
    s_waitcnt lgkmcnt(0)
    v_mfma_f32_16x16x32_bf16 v[32:35], a[0:3], a[72:75], v[32:35]
    ds_read_b64_tr_b16 a[32:33], v22 offset:28672
    ds_read_b64_tr_b16 a[34:35], v22 offset:29184
    v_mfma_f32_16x16x32_bf16 v[36:39], a[4:7], a[72:75], v[36:39]
    ds_read_b64_tr_b16 a[36:37], v23 offset:28672
    ds_read_b64_tr_b16 a[38:39], v23 offset:29184
    v_mfma_f32_16x16x32_bf16 v[40:43], a[8:11], a[72:75], v[40:43]
    ds_read_b64_tr_b16 a[40:41], v24 offset:28672
    ds_read_b64_tr_b16 a[42:43], v24 offset:29184
    v_mfma_f32_16x16x32_bf16 v[68:71], v[76:79], a[72:75], v[68:71]
    ds_read_b64_tr_b16 a[44:45], v25 offset:28672
    ds_read_b64_tr_b16 a[46:47], v25 offset:29184
    v_mfma_f32_16x16x32_bf16 v[44:47], a[12:15], a[72:75], v[44:47]
    ds_read_b64_tr_b16 a[48:49], v22 offset:61440
    ds_read_b64_tr_b16 a[50:51], v22 offset:61952
    v_mfma_f32_16x16x32_bf16 v[48:51], a[16:19], a[72:75], v[48:51]
    ds_read_b64_tr_b16 a[52:53], v23 offset:61440
    ds_read_b64_tr_b16 a[54:55], v23 offset:61952
    v_mfma_f32_16x16x32_bf16 v[52:55], a[20:23], a[72:75], v[52:55]
    ds_read_b64_tr_b16 a[56:57], v24 offset:61440
    ds_read_b64_tr_b16 a[58:59], v24 offset:61952
    v_mfma_f32_16x16x32_bf16 v[72:75], a[72:75], a[72:75], v[72:75]
    ds_read_b64_tr_b16 a[60:61], v25 offset:61440
    ds_read_b64_tr_b16 a[62:63], v25 offset:61952
    v_mfma_f32_16x16x32_bf16 v[56:59], a[24:27], a[72:75], v[56:59]
    v_mfma_f32_16x16x32_bf16 v[60:63], a[28:31], a[72:75], v[60:63]
    s_cmp_lt_u32 s59, 4
    s_cbranch_scc0 L_recurrent_scan__spectral_fnet__mixer_gmlp__prompt_cb_25_1
    v_mfma_f32_16x16x32_bf16 v[64:67], a[0:3], v[76:79], v[64:67]
    s_branch L_recurrent_scan__spectral_fnet__mixer_gmlp__prompt_cb_25_d
L_recurrent_scan__spectral_fnet__mixer_gmlp__prompt_cb_25_1:
    v_mfma_f32_16x16x32_bf16 v[64:67], a[16:19], v[76:79], v[64:67]
L_recurrent_scan__spectral_fnet__mixer_gmlp__prompt_cb_25_d:
    s_waitcnt lgkmcnt(0)
    s_mul_i32 s5, s82, 2
    s_add_u32 m0, s5, s79
    s_nop 0
    buffer_load_dwordx4 v6, s[24:27], s83 offen lds
    buffer_load_dwordx4 v7, s[24:27], s83 offen offset:1024 lds
    s_add_u32 s5, s83, 63488
    buffer_load_dwordx4 v6, s[24:27], s5 offen offset:2048 lds
    buffer_load_dwordx4 v7, s[24:27], s5 offen offset:3072 lds
    s_add_u32 s83, s83, 128
    v_mfma_f32_16x16x32_bf16 v[32:35], a[32:35], a[76:79], v[32:35]
    v_mfma_f32_16x16x32_bf16 v[36:39], a[36:39], a[76:79], v[36:39]
    v_mfma_f32_16x16x32_bf16 v[40:43], a[40:43], a[76:79], v[40:43]
    v_mfma_f32_16x16x32_bf16 v[68:71], v[76:79], a[76:79], v[68:71]
    v_mfma_f32_16x16x32_bf16 v[44:47], a[44:47], a[76:79], v[44:47]
    v_mfma_f32_16x16x32_bf16 v[48:51], a[48:51], a[76:79], v[48:51]
    v_mfma_f32_16x16x32_bf16 v[52:55], a[52:55], a[76:79], v[52:55]
    v_mfma_f32_16x16x32_bf16 v[72:75], a[76:79], a[76:79], v[72:75]
    v_mfma_f32_16x16x32_bf16 v[56:59], a[56:59], a[76:79], v[56:59]
    v_mfma_f32_16x16x32_bf16 v[60:63], a[60:63], a[76:79], v[60:63]
    s_cmp_lt_u32 s59, 4
    s_cbranch_scc0 L_recurrent_scan__spectral_fnet__mixer_gmlp__prompt_cb_26_1
    v_mfma_f32_16x16x32_bf16 v[64:67], a[32:35], v[76:79], v[64:67]
    s_branch L_recurrent_scan__spectral_fnet__mixer_gmlp__prompt_cb_26_d
L_recurrent_scan__spectral_fnet__mixer_gmlp__prompt_cb_26_1:
    v_mfma_f32_16x16x32_bf16 v[64:67], a[48:51], v[76:79], v[64:67]
L_recurrent_scan__spectral_fnet__mixer_gmlp__prompt_cb_26_d:
    s_lshr_b32 s4, s59, 2
    s_lshl_b32 s4, s4, 9
    s_lshl_b32 s5, s64, 6
    s_add_u32 s4, s4, s5
    v_add_u32 v116, s4, v14
    s_nop 2
    ds_write_b128 v116, v[64:67]
    ds_write_b128 v116, v[64:67] offset:256
    v_and_b32 v117, 3, v3
    v_lshrrev_b32 v118, 2, v3
    v_mov_b32 v119, v72
    v_cmp_eq_u32 vcc, 1, v117
    s_nop 1
    v_cndmask_b32 v119, v119, v73, vcc
    v_cmp_eq_u32 vcc, 2, v117
    s_nop 1
    v_cndmask_b32 v119, v119, v74, vcc
    v_cmp_eq_u32 vcc, 3, v117
    s_nop 1
    v_cndmask_b32 v119, v119, v75, vcc
    v_cmp_eq_u32 vcc, v118, v2
    s_nop 1
    v_cndmask_b32 v119, 0, v119, vcc
    v_mov_b32 v120, v119
    s_nop 1
    v_permlane16_swap_b32 v119, v120
    v_add_f32 v119, v119, v120
    v_mov_b32 v120, v119
    s_nop 1
    v_permlane32_swap_b32 v119, v120
    v_add_f32 v119, v119, v120
    v_mul_f32 v80, 989855744, v68
    v_mul_f32 v119, 989855744, v119
    v_fma_f32 v119, -v80, v80, v119
    v_max_f32 v119, 0, v119
    v_add_f32 v119, 925353388, v119
    v_rsq_f32 v81, v119
    s_lshl_b32 s5, s64, 6
    v_add_u32 v116, s5, v14
    s_waitcnt lgkmcnt(0)
    s_barrier
    ds_read_b128 v[84:87], v116 offset:0
    ds_read_b128 v[88:91], v116 offset:64
    ds_read_b128 v[92:95], v116 offset:128
    ds_read_b128 v[96:99], v116 offset:192
    ds_read_b128 v[100:103], v116 offset:512
    ds_read_b128 v[104:107], v116 offset:576
    ds_read_b128 v[108:111], v116 offset:640
    ds_read_b128 v[112:115], v116 offset:704
    s_mul_i32 s5, s82, 3
    s_add_u32 m0, s5, s79
    s_nop 0
    buffer_load_dwordx4 v6, s[24:27], s83 offen lds
    buffer_load_dwordx4 v7, s[24:27], s83 offen offset:1024 lds
    s_add_u32 s5, s83, 63488
    buffer_load_dwordx4 v6, s[24:27], s5 offen offset:2048 lds
    buffer_load_dwordx4 v7, s[24:27], s5 offen offset:3072 lds
    s_add_u32 s83, s83, 128
    s_waitcnt lgkmcnt(0)
    v_fma_f32 v32, -v80, v84, v32
    v_fma_f32 v33, -v80, v85, v33
    v_fma_f32 v34, -v80, v86, v34
    v_fma_f32 v35, -v80, v87, v35
    v_fma_f32 v36, -v80, v88, v36
    v_fma_f32 v37, -v80, v89, v37
    v_fma_f32 v38, -v80, v90, v38
    v_fma_f32 v39, -v80, v91, v39
    v_fma_f32 v40, -v80, v92, v40
    v_fma_f32 v41, -v80, v93, v41
    v_fma_f32 v42, -v80, v94, v42
    v_fma_f32 v43, -v80, v95, v43
    v_fma_f32 v44, -v80, v96, v44
    v_fma_f32 v45, -v80, v97, v45
    v_fma_f32 v46, -v80, v98, v46
    v_fma_f32 v47, -v80, v99, v47
    v_mul_f32 v32, v32, v81
    v_mul_f32 v33, v33, v81
    v_mul_f32 v34, v34, v81
    v_mul_f32 v35, v35, v81
    v_mul_f32 v36, v36, v81
    v_mul_f32 v37, v37, v81
    v_mul_f32 v38, v38, v81
    v_mul_f32 v39, v39, v81
    v_mul_f32 v40, v40, v81
    v_mul_f32 v41, v41, v81
    v_mul_f32 v42, v42, v81
    v_mul_f32 v43, v43, v81
    v_mul_f32 v44, v44, v81
    v_mul_f32 v45, v45, v81
    v_mul_f32 v46, v46, v81
    v_mul_f32 v47, v47, v81
    s_cmp_eq_u32 s74, 0
    s_cbranch_scc0 L_recurrent_scan__spectral_fnet__mixer_gmlp__prompt_e1_27_ab
    v_mul_f32 v116, v32, v32
    v_mul_f32 v117, v33, v33
    v_mul_f32 v118, v34, v34
    v_mul_f32 v119, v35, v35
    v_mul_f32 v120, v36, v36
    v_mul_f32 v121, v37, v37
    v_mul_f32 v122, v38, v38
    v_mul_f32 v123, v39, v39
    v_fma_f32 v116, v116, v5, v4
    v_fma_f32 v117, v117, v5, v4
    v_fma_f32 v118, v118, v5, v4
    v_fma_f32 v119, v119, v5, v4
    v_fma_f32 v120, v120, v5, v4
    v_fma_f32 v121, v121, v5, v4
    v_fma_f32 v122, v122, v5, v4
    v_fma_f32 v123, v123, v5, v4
    v_mul_f32 v116, v116, v32
    v_mul_f32 v117, v117, v33
    v_mul_f32 v118, v118, v34
    v_mul_f32 v119, v119, v35
    v_mul_f32 v120, v120, v36
    v_mul_f32 v121, v121, v37
    v_mul_f32 v122, v122, v38
    v_mul_f32 v123, v123, v39
    v_exp_f32 v116, v116
    v_exp_f32 v117, v117
    v_exp_f32 v118, v118
    v_exp_f32 v119, v119
    v_exp_f32 v120, v120
    v_exp_f32 v121, v121
    v_exp_f32 v122, v122
    v_exp_f32 v123, v123
    v_add_f32 v116, 1.0, v116
    v_add_f32 v117, 1.0, v117
    v_add_f32 v118, 1.0, v118
    v_add_f32 v119, 1.0, v119
    v_add_f32 v120, 1.0, v120
    v_add_f32 v121, 1.0, v121
    v_add_f32 v122, 1.0, v122
    v_add_f32 v123, 1.0, v123
    v_rcp_f32 v116, v116
    v_rcp_f32 v117, v117
    v_rcp_f32 v118, v118
    v_rcp_f32 v119, v119
    v_rcp_f32 v120, v120
    v_rcp_f32 v121, v121
    v_rcp_f32 v122, v122
    v_rcp_f32 v123, v123
    v_mul_f32 v84, v32, v116
    v_mul_f32 v85, v33, v117
    v_mul_f32 v86, v34, v118
    v_mul_f32 v87, v35, v119
    v_mul_f32 v88, v36, v120
    v_mul_f32 v89, v37, v121
    v_mul_f32 v90, v38, v122
    v_mul_f32 v91, v39, v123
    v_mul_f32 v116, v40, v40
    v_mul_f32 v117, v41, v41
    v_mul_f32 v118, v42, v42
    v_mul_f32 v119, v43, v43
    v_mul_f32 v120, v44, v44
    v_mul_f32 v121, v45, v45
    v_mul_f32 v122, v46, v46
    v_mul_f32 v123, v47, v47
    v_fma_f32 v116, v116, v5, v4
    v_fma_f32 v117, v117, v5, v4
    v_fma_f32 v118, v118, v5, v4
    v_fma_f32 v119, v119, v5, v4
    v_fma_f32 v120, v120, v5, v4
    v_fma_f32 v121, v121, v5, v4
    v_fma_f32 v122, v122, v5, v4
    v_fma_f32 v123, v123, v5, v4
    v_mul_f32 v116, v116, v40
    v_mul_f32 v117, v117, v41
    v_mul_f32 v118, v118, v42
    v_mul_f32 v119, v119, v43
    v_mul_f32 v120, v120, v44
    v_mul_f32 v121, v121, v45
    v_mul_f32 v122, v122, v46
    v_mul_f32 v123, v123, v47
    v_exp_f32 v116, v116
    v_exp_f32 v117, v117
    v_exp_f32 v118, v118
    v_exp_f32 v119, v119
    v_exp_f32 v120, v120
    v_exp_f32 v121, v121
    v_exp_f32 v122, v122
    v_exp_f32 v123, v123
    v_add_f32 v116, 1.0, v116
    v_add_f32 v117, 1.0, v117
    v_add_f32 v118, 1.0, v118
    v_add_f32 v119, 1.0, v119
    v_add_f32 v120, 1.0, v120
    v_add_f32 v121, 1.0, v121
    v_add_f32 v122, 1.0, v122
    v_add_f32 v123, 1.0, v123
    v_rcp_f32 v116, v116
    v_rcp_f32 v117, v117
    v_rcp_f32 v118, v118
    v_rcp_f32 v119, v119
    v_rcp_f32 v120, v120
    v_rcp_f32 v121, v121
    v_rcp_f32 v122, v122
    v_rcp_f32 v123, v123
    v_mul_f32 v92, v40, v116
    v_mul_f32 v93, v41, v117
    v_mul_f32 v94, v42, v118
    v_mul_f32 v95, v43, v119
    v_mul_f32 v96, v44, v120
    v_mul_f32 v97, v45, v121
    v_mul_f32 v98, v46, v122
    v_mul_f32 v99, v47, v123
    v_mov_b32 v68, 0
    v_mov_b32 v69, 0
    s_lshl_b32 s5, s76, 2
    s_add_u32 s5, s5, s64
    s_sub_u32 s5, s5, 43
    s_cmp_lt_u32 s5, 43
    s_cbranch_scc0 L_recurrent_scan__spectral_fnet__mixer_gmlp__prompt_va_28
    v_add_f32 v116, v84, v85
    v_add_f32 v117, v86, v87
    v_mul_f32 v118, v84, v84
    v_mul_f32 v119, v86, v86
    v_fmac_f32 v118, v85, v85
    v_fmac_f32 v119, v87, v87
    v_add_f32 v116, v116, v117
    v_add_f32 v118, v118, v119
    v_add_f32 v68, v68, v116
    v_add_f32 v69, v69, v118
L_recurrent_scan__spectral_fnet__mixer_gmlp__prompt_va_28:
    s_lshl_b32 s5, s76, 2
    s_add_u32 s5, s5, s65
    s_sub_u32 s5, s5, 43
    s_cmp_lt_u32 s5, 43
    s_cbranch_scc0 L_recurrent_scan__spectral_fnet__mixer_gmlp__prompt_va_29
    v_add_f32 v116, v88, v89
    v_add_f32 v117, v90, v91
    v_mul_f32 v118, v88, v88
    v_mul_f32 v119, v90, v90
    v_fmac_f32 v118, v89, v89
    v_fmac_f32 v119, v91, v91
    v_add_f32 v116, v116, v117
    v_add_f32 v118, v118, v119
    v_add_f32 v68, v68, v116
    v_add_f32 v69, v69, v118
L_recurrent_scan__spectral_fnet__mixer_gmlp__prompt_va_29:
    s_lshl_b32 s5, s76, 2
    s_add_u32 s5, s5, s66
    s_sub_u32 s5, s5, 43
    s_cmp_lt_u32 s5, 43
    s_cbranch_scc0 L_recurrent_scan__spectral_fnet__mixer_gmlp__prompt_va_30
    v_add_f32 v116, v92, v93
    v_add_f32 v117, v94, v95
    v_mul_f32 v118, v92, v92
    v_mul_f32 v119, v94, v94
    v_fmac_f32 v118, v93, v93
    v_fmac_f32 v119, v95, v95
    v_add_f32 v116, v116, v117
    v_add_f32 v118, v118, v119
    v_add_f32 v68, v68, v116
    v_add_f32 v69, v69, v118
L_recurrent_scan__spectral_fnet__mixer_gmlp__prompt_va_30:
    s_lshl_b32 s5, s76, 2
    s_add_u32 s5, s5, s67
    s_sub_u32 s5, s5, 43
    s_cmp_lt_u32 s5, 43
    s_cbranch_scc0 L_recurrent_scan__spectral_fnet__mixer_gmlp__prompt_va_31
    v_add_f32 v116, v96, v97
    v_add_f32 v117, v98, v99
    v_mul_f32 v118, v96, v96
    v_mul_f32 v119, v98, v98
    v_fmac_f32 v118, v97, v97
    v_fmac_f32 v119, v99, v99
    v_add_f32 v116, v116, v117
    v_add_f32 v118, v118, v119
    v_add_f32 v68, v68, v116
    v_add_f32 v69, v69, v118
L_recurrent_scan__spectral_fnet__mixer_gmlp__prompt_va_31:
    v_mov_b32 v116, v68
    v_mov_b32 v117, v69
    s_nop 0
    v_permlane16_swap_b32 v68, v116
    v_permlane16_swap_b32 v69, v117
    v_add_f32 v68, v68, v116
    v_add_f32 v69, v69, v117
    v_mov_b32 v116, v68
    v_mov_b32 v117, v69
    s_nop 0
    v_permlane32_swap_b32 v68, v116
    v_permlane32_swap_b32 v69, v117
    v_add_f32 v68, v68, v116
    v_add_f32 v69, v69, v117
    v_mov_b32 v120, v68
    v_mov_b32 v121, s58
    v_mov_b32 v122, v69
    v_mov_b32 v123, s58
    s_mul_i32 s4, s60, 12
    s_add_u32 s4, s4, s61
    s_lshl_b32 s4, s4, 11
    s_lshl_b32 s5, s59, 8
    s_add_u32 s4, s4, s5
    s_add_u32 s4, s4, 262144
    v_lshlrev_b32 v116, 4, v3
    s_mov_b64 exec, 0xffff
    buffer_store_dwordx4 v[120:123], v116, s[16:19], s4 offen sc1
    s_mov_b64 exec, -1
    v_fma_f32 v48, -v80, v100, v48
    v_fma_f32 v49, -v80, v101, v49
    v_fma_f32 v50, -v80, v102, v50
    v_fma_f32 v51, -v80, v103, v51
    v_fma_f32 v52, -v80, v104, v52
    v_fma_f32 v53, -v80, v105, v53
    v_fma_f32 v54, -v80, v106, v54
    v_fma_f32 v55, -v80, v107, v55
    v_fma_f32 v56, -v80, v108, v56
    v_fma_f32 v57, -v80, v109, v57
    v_fma_f32 v58, -v80, v110, v58
    v_fma_f32 v59, -v80, v111, v59
    v_fma_f32 v60, -v80, v112, v60
    v_fma_f32 v61, -v80, v113, v61
    v_fma_f32 v62, -v80, v114, v62
    v_fma_f32 v63, -v80, v115, v63
    v_mul_f32 v48, v48, v81
    v_mul_f32 v49, v49, v81
    v_mul_f32 v50, v50, v81
    v_mul_f32 v51, v51, v81
    v_mul_f32 v52, v52, v81
    v_mul_f32 v53, v53, v81
    v_mul_f32 v54, v54, v81
    v_mul_f32 v55, v55, v81
    v_mul_f32 v56, v56, v81
    v_mul_f32 v57, v57, v81
    v_mul_f32 v58, v58, v81
    v_mul_f32 v59, v59, v81
    v_mul_f32 v60, v60, v81
    v_mul_f32 v61, v61, v81
    v_mul_f32 v62, v62, v81
    v_mul_f32 v63, v63, v81
    s_cmp_eq_u32 s75, 1
    s_cbranch_scc0 L_recurrent_scan__spectral_fnet__mixer_gmlp__prompt_e2_32_z1
    s_lshl_b32 s78, s77, 6
    s_add_u32 s78, s78, 2048
    v_cvt_pk_bf16_f32 v116, v48, v49
    v_cvt_pk_bf16_f32 v117, v50, v51
    ds_write_b16 v26, v116
    ds_write_b16_d16_hi v26, v116 offset:272
    ds_write_b16 v26, v117 offset:544
    ds_write_b16_d16_hi v26, v117 offset:816
    v_cvt_pk_bf16_f32 v118, v52, v53
    v_cvt_pk_bf16_f32 v119, v54, v55
    ds_write_b16 v27, v118
    ds_write_b16_d16_hi v27, v118 offset:272
    ds_write_b16 v27, v119 offset:544
    ds_write_b16_d16_hi v27, v119 offset:816
    v_cvt_pk_bf16_f32 v120, v56, v57
    v_cvt_pk_bf16_f32 v121, v58, v59
    ds_write_b16 v28, v120
    ds_write_b16_d16_hi v28, v120 offset:272
    ds_write_b16 v28, v121 offset:544
    ds_write_b16_d16_hi v28, v121 offset:816
    v_cvt_pk_bf16_f32 v122, v60, v61
    v_cvt_pk_bf16_f32 v123, v62, v63
    ds_write_b16 v29, v122
    ds_write_b16_d16_hi v29, v122 offset:272
    ds_write_b16 v29, v123 offset:544
    ds_write_b16_d16_hi v29, v123 offset:816
    s_waitcnt lgkmcnt(0)
    s_barrier
    ds_read_b128 v[116:119], v30 offset:0
    ds_read_b128 v[120:123], v30 offset:1088
    s_lshl_b32 s4, s60, 8
    s_lshl_b32 s5, s59, 3
    s_add_u32 s5, s5, s78
    s_lshl_b32 s5, s5, 12
    s_add_u32 s4, s4, s5
    s_waitcnt lgkmcnt(0)
    buffer_store_dwordx4 v[116:119], v31, s[16:19], s4 offen sc1
    s_add_u32 s4, s4, 16384
    buffer_store_dwordx4 v[120:123], v31, s[16:19], s4 offen sc1
L_recurrent_scan__spectral_fnet__mixer_gmlp__prompt_ts_33:
    s_waitcnt lgkmcnt(0)
    s_branch L_recurrent_scan__spectral_fnet__mixer_gmlp__prompt_e2_32_d
L_recurrent_scan__spectral_fnet__mixer_gmlp__prompt_e2_32_z1:
    v_lshrrev_b32 v10, 1, v2
    v_and_b32 v11, 7, v3
    v_xor_b32 v10, v10, v11
    v_and_b32 v11, 1, v2
    v_lshl_add_u32 v11, v11, 3, v15
    v_cvt_pk_bf16_f32 v116, v48, v49
    v_cvt_pk_bf16_f32 v117, v50, v51
    s_lshl_b32 s5, s64, 1
    v_xor_b32 v124, s5, v10
    v_lshl_add_u32 v124, v124, 4, v11
    ds_write_b64 v124, v[116:117]
    v_cvt_pk_bf16_f32 v118, v52, v53
    v_cvt_pk_bf16_f32 v119, v54, v55
    s_lshl_b32 s5, s65, 1
    v_xor_b32 v124, s5, v10
    v_lshl_add_u32 v124, v124, 4, v11
    ds_write_b64 v124, v[118:119]
    v_cvt_pk_bf16_f32 v120, v56, v57
    v_cvt_pk_bf16_f32 v121, v58, v59
    s_lshl_b32 s5, s66, 1
    v_xor_b32 v124, s5, v10
    v_lshl_add_u32 v124, v124, 4, v11
    ds_write_b64 v124, v[120:121]
    v_cvt_pk_bf16_f32 v122, v60, v61
    v_cvt_pk_bf16_f32 v123, v62, v63
    s_lshl_b32 s5, s67, 1
    v_xor_b32 v124, s5, v10
    v_lshl_add_u32 v124, v124, 4, v11
    ds_write_b64 v124, v[122:123]
    s_waitcnt lgkmcnt(0)
    ds_read_b128 v[116:119], v12 offset:0
    ds_read_b128 v[120:123], v12 offset:1024
    s_lshl_b32 s4, s60, 7
    s_lshl_b32 s5, s59, 4
    s_add_u32 s4, s4, s5
    s_mul_i32 s4, s4, 1408
    s_lshl_b32 s5, s77, 7
    s_add_u32 s4, s4, s5
    s_add_u32 s4, s4, 5242880
    s_waitcnt lgkmcnt(0)
    buffer_store_dwordx4 v[116:119], v13, s[16:19], s4 offen sc1
    s_add_u32 s4, s4, 11264
    buffer_store_dwordx4 v[120:123], v13, s[16:19], s4 offen sc1
    s_nop 1
L_recurrent_scan__spectral_fnet__mixer_gmlp__prompt_e2_32_d:
    s_waitcnt vmcnt(15)
    s_mul_i32 s5, s82, 0
    s_add_u32 s5, s5, s79
    v_xor_b32 v124, 0, v8
    v_add_u32 v124, s5, v124
    v_xor_b32 v125, 32, v8
    v_add_u32 v125, s5, v125
    v_xor_b32 v126, 64, v8
    v_add_u32 v126, s5, v126
    v_xor_b32 v127, 96, v8
    v_add_u32 v127, s5, v127
    ds_read_b128 a[0:3], v124
    ds_read_b128 a[4:7], v125
    ds_read_b128 a[8:11], v126
    ds_read_b128 a[12:15], v127
    s_waitcnt vmcnt(11)
    s_mul_i32 s5, s82, 1
    s_add_u32 s5, s5, s79
    v_xor_b32 v124, 0, v8
    v_add_u32 v124, s5, v124
    v_xor_b32 v125, 32, v8
    v_add_u32 v125, s5, v125
    v_xor_b32 v126, 64, v8
    v_add_u32 v126, s5, v126
    v_xor_b32 v127, 96, v8
    v_add_u32 v127, s5, v127
    ds_read_b128 a[16:19], v124
    ds_read_b128 a[20:23], v125
    ds_read_b128 a[24:27], v126
    ds_read_b128 a[28:31], v127
    s_waitcnt vmcnt(7)
    s_mul_i32 s5, s82, 2
    s_add_u32 s5, s5, s79
    v_xor_b32 v124, 0, v8
    v_add_u32 v124, s5, v124
    v_xor_b32 v125, 32, v8
    v_add_u32 v125, s5, v125
    v_xor_b32 v126, 64, v8
    v_add_u32 v126, s5, v126
    v_xor_b32 v127, 96, v8
    v_add_u32 v127, s5, v127
    ds_read_b128 a[32:35], v124
    ds_read_b128 a[36:39], v125
    ds_read_b128 a[40:43], v126
    ds_read_b128 a[44:47], v127
    s_waitcnt vmcnt(3)
    s_mul_i32 s5, s82, 3
    s_add_u32 s5, s5, s79
    v_xor_b32 v124, 0, v8
    v_add_u32 v124, s5, v124
    v_xor_b32 v125, 32, v8
    v_add_u32 v125, s5, v125
    v_xor_b32 v126, 64, v8
    v_add_u32 v126, s5, v126
    v_xor_b32 v127, 96, v8
    v_add_u32 v127, s5, v127
    ds_read_b128 a[48:51], v124
    ds_read_b128 a[52:55], v125
    ds_read_b128 a[56:59], v126
    ds_read_b128 a[60:63], v127
    s_waitcnt lgkmcnt(0)
    s_mul_i32 s5, s82, 0
    s_add_u32 m0, s5, s79
    s_nop 0
    buffer_load_dwordx4 v6, s[24:27], s83 offen lds
    buffer_load_dwordx4 v7, s[24:27], s83 offen offset:1024 lds
    s_add_u32 s5, s83, 63488
    buffer_load_dwordx4 v6, s[24:27], s5 offen offset:2048 lds
    buffer_load_dwordx4 v7, s[24:27], s5 offen offset:3072 lds
    s_add_u32 s83, s83, 128
    s_mul_i32 s5, s82, 1
    s_add_u32 m0, s5, s79
    s_nop 0
    buffer_load_dwordx4 v6, s[24:27], s83 offen lds
    buffer_load_dwordx4 v7, s[24:27], s83 offen offset:1024 lds
    s_add_u32 s5, s83, 63488
    buffer_load_dwordx4 v6, s[24:27], s5 offen offset:2048 lds
    buffer_load_dwordx4 v7, s[24:27], s5 offen offset:3072 lds
    s_add_u32 s83, s83, 128
    s_cmp_lt_u32 s59, 4
    s_cbranch_scc0 L_recurrent_scan__spectral_fnet__mixer_gmlp__prompt_fc_34
    s_lshl_b32 s4, s59, 4
    v_add_u32 v10, s4, v3
    v_lshlrev_b32 v11, 2, v2
    v_add_u32 v103, 0, v11
    v_mul_u32_u24 v103, v103, v10
    v_cvt_f32_u32 v103, v103
    v_mul_f32 v103, 973078528, v103
    v_cos_f32 v16, v103
    v_sin_f32 v24, v103
    v_add_u32 v103, 1, v11
    v_mul_u32_u24 v103, v103, v10
    v_cvt_f32_u32 v103, v103
    v_mul_f32 v103, 973078528, v103
    v_cos_f32 v17, v103
    v_sin_f32 v25, v103
    v_add_u32 v103, 2, v11
    v_mul_u32_u24 v103, v103, v10
    v_cvt_f32_u32 v103, v103
    v_mul_f32 v103, 973078528, v103
    v_cos_f32 v18, v103
    v_sin_f32 v79, v103
    v_add_u32 v103, 3, v11
    v_mul_u32_u24 v103, v103, v10
    v_cvt_f32_u32 v103, v103
    v_mul_f32 v103, 973078528, v103
    v_cos_f32 v19, v103
    v_sin_f32 v82, v103
    v_add_u32 v103, 16, v11
    v_mul_u32_u24 v103, v103, v10
    v_cvt_f32_u32 v103, v103
    v_mul_f32 v103, 973078528, v103
    v_cos_f32 v20, v103
    v_sin_f32 v83, v103
    v_add_u32 v103, 17, v11
    v_mul_u32_u24 v103, v103, v10
    v_cvt_f32_u32 v103, v103
    v_mul_f32 v103, 973078528, v103
    v_cos_f32 v21, v103
    v_sin_f32 v100, v103
    v_add_u32 v103, 18, v11
    v_mul_u32_u24 v103, v103, v10
    v_cvt_f32_u32 v103, v103
    v_mul_f32 v103, 973078528, v103
    v_cos_f32 v22, v103
    v_sin_f32 v101, v103
    v_add_u32 v103, 19, v11
    v_mul_u32_u24 v103, v103, v10
    v_cvt_f32_u32 v103, v103
    v_mul_f32 v103, 973078528, v103
    v_cos_f32 v23, v103
    v_sin_f32 v102, v103
    v_lshrrev_b32 v11, 2, v3
    v_lshl_add_u32 v11, v2, 3, v11
    v_lshlrev_b32 v11, 6, v11
    v_and_b32 v103, 3, v3
    v_lshl_add_u32 v11, v103, 3, v11
    v_add_u32 v76, 147456, v11
    s_lshl_b32 s4, s59, 4
    v_lshlrev_b32 v11, 2, v2
    v_add_u32 v11, s4, v11
    v_lshl_add_u32 v78, v3, 6, v11
    v_lshlrev_b32 v11, 1, v78
    v_add_u32 v77, 155648, v11
L_recurrent_scan__spectral_fnet__mixer_gmlp__prompt_fc_34:
    s_lshr_b32 s66, s59, 2
    s_and_b32 s67, s59, 3
    v_and_b32 v10, 7, v1
    v_lshrrev_b32 v11, 4, v1
    v_xor_b32 v10, v10, v11
    v_lshrrev_b32 v11, 3, v1
    v_lshlrev_b32 v12, 12, v11
    v_lshl_add_u32 v13, v10, 4, v12
    v_xor_b32 v10, 4, v10
    v_lshl_add_u32 v14, v10, 4, v12
    v_add_u32 v104, 0, v13
    v_add_u32 v105, 31744, v14
    v_add_u32 v106, 63488, v13
    v_add_u32 v107, 95232, v14
    v_add_u32 v108, 131072, v13
    v_add_u32 v109, 162816, v14
    s_mul_i32 s4, s63, 96
    s_mul_i32 s5, s66, 48
    s_add_u32 s4, s4, s5
    s_lshl_b32 s4, s4, 12
    s_lshl_b32 s5, s67, 10
    s_add_u32 s64, s4, s5
    s_mul_i32 s4, s67, 12288
    s_mul_i32 s5, s66, 6144
    s_add_u32 s65, s4, s5
    v_and_b32 v10, 31, v1
    v_lshrrev_b32 v11, 1, v10
    v_and_b32 v11, 7, v11
    v_lshrrev_b32 v12, 5, v1
    v_xor_b32 v11, v11, v12
    v_lshlrev_b32 v10, 7, v10
    v_lshl_add_u32 v10, v11, 4, v10
    v_xor_b32 v110, 0, v10
    v_add_u32 v110, s4, v110
    v_xor_b32 v111, 32, v10
    v_add_u32 v111, s4, v111
    v_xor_b32 v112, 64, v10
    v_add_u32 v112, s4, v112
    v_xor_b32 v113, 96, v10
    v_add_u32 v113, s4, v113
    s_mul_i32 s4, s63, 96
    s_add_u32 s5, s4, 48
    s_lshr_b32 s5, s5, 6
    v_lshrrev_b32 v10, 4, v1
    v_add_u32 v10, s5, v10
    v_min_u32 v10, 11, v10
    v_and_b32 v11, 15, v1
    v_lshl_add_u32 v10, v10, 4, v11
    v_lshlrev_b32 v10, 7, v10
    v_add_u32 v10, 4096, v10
    s_lshr_b32 s4, s4, 6
    s_sub_u32 s4, s4, 48
    v_add_u32 v11, s4, v1
    v_min_u32 v11, 10, v11
    s_lshr_b32 s5, s62, 1
    v_lshlrev_b32 v11, 4, v11
    v_add_u32 v11, s5, v11
    v_lshlrev_b32 v11, 7, v11
    v_add_u32 v11, 53248, v11
    v_cmp_lt_u32 vcc, 47, v1
    s_nop 1
    v_cndmask_b32 v114, v10, v11, vcc
    s_lshr_b32 s4, s2, 6
    s_cmp_eq_u32 s2, 0
    s_cselect_b32 s5, 4, s4
    s_add_u32 s4, s4, 5
    v_mov_b32 v115, s5
    v_mov_b32 v11, s4
    v_and_b32 v13, 31, v1
    v_cmp_lt_u32 vcc, 15, v13
    s_nop 1
    v_cndmask_b32 v115, v115, v11, vcc
    v_lshlrev_b32 v115, 4, v115
    v_add_u32 v115, v115, v3
    v_lshlrev_b32 v115, 7, v115
    v_add_u32 v115, 32768, v115
    v_lshlrev_b32 v10, 4, v3
    v_lshl_add_u32 v10, v2, 11, v10
    s_mul_i32 s4, s60, 24576
    s_lshl_b32 s5, s59, 8
    s_add_u32 s4, s4, s5
    s_add_u32 s4, s4, 262144
    s_mov_b32 s6, 0
L_recurrent_scan__spectral_fnet__mixer_gmlp__prompt_pl_35:
    s_mov_b32 s5, s4
    buffer_load_dwordx4 v[32:35], v10, s[16:19], s5 offen sc1
    s_add_u32 s5, s5, 8192
    buffer_load_dwordx4 v[36:39], v10, s[16:19], s5 offen sc1
    s_add_u32 s5, s5, 8192
    buffer_load_dwordx4 v[40:43], v10, s[16:19], s5 offen sc1
    s_waitcnt vmcnt(0)
    v_xor_b32 v11, s58, v33
    v_xor_b32 v116, s58, v35
    v_or_b32 v11, v11, v116
    v_xor_b32 v116, s58, v37
    v_or_b32 v11, v11, v116
    v_xor_b32 v116, s58, v39
    v_or_b32 v11, v11, v116
    v_xor_b32 v116, s58, v41
    v_or_b32 v11, v11, v116
    v_xor_b32 v116, s58, v43
    v_or_b32 v11, v11, v116
    v_cmp_ne_u32 vcc, 0, v11
    s_add_u32 s6, s6, 1
    s_cmp_gt_u32 s6, 200000
    s_cbranch_scc1 L_recurrent_scan__spectral_fnet__mixer_gmlp__prompt_pl_35_d
    s_cbranch_vccnz L_recurrent_scan__spectral_fnet__mixer_gmlp__prompt_pl_35
L_recurrent_scan__spectral_fnet__mixer_gmlp__prompt_pl_35_d:
    v_add_f32 v32, v32, v36
    v_add_f32 v34, v34, v38
    v_add_f32 v32, v32, v40
    v_add_f32 v34, v34, v42
    v_mov_b32 v33, v32
    v_mov_b32 v35, v34
    s_nop 0
    v_permlane16_swap_b32 v32, v33
    v_permlane16_swap_b32 v34, v35
    v_add_f32 v32, v32, v33
    v_add_f32 v34, v34, v35
    v_mov_b32 v33, v32
    v_mov_b32 v35, v34
    s_nop 0
    v_permlane32_swap_b32 v32, v33
    v_permlane32_swap_b32 v34, v35
    v_add_f32 v32, v32, v33
    v_add_f32 v34, v34, v35
    v_mul_f32 v32, 985563898, v32
    v_mul_f32 v34, 985563898, v34
    v_fma_f32 v34, -v32, v32, v34
    v_max_f32 v34, 0, v34
    v_add_f32 v34, 925353388, v34
    v_rsq_f32 v33, v34
    v_sub_f32 v84, v84, v32
    v_sub_f32 v85, v85, v32
    v_sub_f32 v86, v86, v32
    v_sub_f32 v87, v87, v32
    v_sub_f32 v88, v88, v32
    v_sub_f32 v89, v89, v32
    v_sub_f32 v90, v90, v32
    v_sub_f32 v91, v91, v32
    v_sub_f32 v92, v92, v32
    v_sub_f32 v93, v93, v32
    v_sub_f32 v94, v94, v32
    v_sub_f32 v95, v95, v32
    v_sub_f32 v96, v96, v32
    v_sub_f32 v97, v97, v32
    v_sub_f32 v98, v98, v32
    v_sub_f32 v99, v99, v32
    v_mul_f32 v84, v84, v33
    v_mul_f32 v85, v85, v33
    v_mul_f32 v86, v86, v33
    v_mul_f32 v87, v87, v33
    v_mul_f32 v88, v88, v33
    v_mul_f32 v89, v89, v33
    v_mul_f32 v90, v90, v33
    v_mul_f32 v91, v91, v33
    v_mul_f32 v92, v92, v33
    v_mul_f32 v93, v93, v33
    v_mul_f32 v94, v94, v33
    v_mul_f32 v95, v95, v33
    v_mul_f32 v96, v96, v33
    v_mul_f32 v97, v97, v33
    v_mul_f32 v98, v98, v33
    v_mul_f32 v99, v99, v33
    s_barrier
    s_cmp_eq_u32 s75, 1
    s_mov_b32 s6, s77
    s_mov_b32 s5, 53248
    s_cselect_b32 s5, 32768, s5
    s_lshl_b32 s6, s6, 4
    s_add_u32 s6, s6, s60
    s_lshl_b32 s6, s6, 7
    s_add_u32 s6, s6, s5
    s_cmp_lg_u32 s59, 7
    s_cbranch_scc1 L_recurrent_scan__spectral_fnet__mixer_gmlp__prompt_fl_36
    v_mov_b32 v10, s58
    v_mov_b32 v11, s6
    s_mov_b64 exec, 1
    buffer_store_dword v10, v11, s[16:19], 0 offen sc1
    s_mov_b64 exec, -1
L_recurrent_scan__spectral_fnet__mixer_gmlp__prompt_fl_36:
    s_lshl_b32 s78, s76, 6
    s_sub_u32 s78, s78, 688
    v_cvt_pk_bf16_f32 v116, v84, v85
    v_cvt_pk_bf16_f32 v117, v86, v87
    ds_write_b16 v26, v116
    ds_write_b16_d16_hi v26, v116 offset:272
    ds_write_b16 v26, v117 offset:544
    ds_write_b16_d16_hi v26, v117 offset:816
    v_cvt_pk_bf16_f32 v118, v88, v89
    v_cvt_pk_bf16_f32 v119, v90, v91
    ds_write_b16 v27, v118
    ds_write_b16_d16_hi v27, v118 offset:272
    ds_write_b16 v27, v119 offset:544
    ds_write_b16_d16_hi v27, v119 offset:816
    v_cvt_pk_bf16_f32 v120, v92, v93
    v_cvt_pk_bf16_f32 v121, v94, v95
    ds_write_b16 v28, v120
    ds_write_b16_d16_hi v28, v120 offset:272
    ds_write_b16 v28, v121 offset:544
    ds_write_b16_d16_hi v28, v121 offset:816
    v_cvt_pk_bf16_f32 v122, v96, v97
    v_cvt_pk_bf16_f32 v123, v98, v99
    ds_write_b16 v29, v122
    ds_write_b16_d16_hi v29, v122 offset:272
    ds_write_b16 v29, v123 offset:544
    ds_write_b16_d16_hi v29, v123 offset:816
    s_waitcnt lgkmcnt(0)
    s_barrier
    ds_read_b128 v[116:119], v30 offset:0
    ds_read_b128 v[120:123], v30 offset:1088
    s_lshl_b32 s4, s60, 8
    s_lshr_b32 s5, s59, 1
    s_lshl_b32 s5, s5, 4
    s_add_u32 s5, s5, s78
    s_cmp_lt_u32 s5, 688
    s_cbranch_scc0 L_recurrent_scan__spectral_fnet__mixer_gmlp__prompt_ts_37
    s_lshl_b32 s5, s59, 3
    s_add_u32 s5, s5, s78
    s_lshl_b32 s5, s5, 12
    s_add_u32 s4, s4, s5
    s_waitcnt lgkmcnt(0)
    buffer_store_dwordx4 v[116:119], v31, s[20:23], s4 offen sc1
    s_add_u32 s4, s4, 16384
    buffer_store_dwordx4 v[120:123], v31, s[20:23], s4 offen sc1
L_recurrent_scan__spectral_fnet__mixer_gmlp__prompt_ts_37:
    s_waitcnt lgkmcnt(0)
    s_waitcnt vmcnt(0)
    s_barrier
    s_cmp_eq_u32 s74, 0
    s_cselect_b32 s6, s61, s76
    s_mov_b32 s5, 32768
    s_cselect_b32 s5, 4096, s5
    s_lshl_b32 s6, s6, 4
    s_add_u32 s6, s6, s60
    s_lshl_b32 s6, s6, 7
    s_add_u32 s6, s6, s5
    s_cmp_lg_u32 s59, 0
    s_cbranch_scc1 L_recurrent_scan__spectral_fnet__mixer_gmlp__prompt_fl_38
    v_mov_b32 v10, s58
    v_mov_b32 v11, s6
    s_mov_b64 exec, 1
    buffer_store_dword v10, v11, s[16:19], 0 offen sc1
    s_mov_b64 exec, -1
L_recurrent_scan__spectral_fnet__mixer_gmlp__prompt_fl_38:
    s_branch L_recurrent_scan__spectral_fnet__mixer_gmlp__prompt_e1_27_d
L_recurrent_scan__spectral_fnet__mixer_gmlp__prompt_e1_27_ab:
    s_lshl_b32 s78, s76, 6
    s_add_u32 s78, s78, 2048
    v_cvt_pk_bf16_f32 v116, v32, v33
    v_cvt_pk_bf16_f32 v117, v34, v35
    ds_write_b16 v26, v116
    ds_write_b16_d16_hi v26, v116 offset:272
    ds_write_b16 v26, v117 offset:544
    ds_write_b16_d16_hi v26, v117 offset:816
    v_cvt_pk_bf16_f32 v118, v36, v37
    v_cvt_pk_bf16_f32 v119, v38, v39
    ds_write_b16 v27, v118
    ds_write_b16_d16_hi v27, v118 offset:272
    ds_write_b16 v27, v119 offset:544
    ds_write_b16_d16_hi v27, v119 offset:816
    v_cvt_pk_bf16_f32 v120, v40, v41
    v_cvt_pk_bf16_f32 v121, v42, v43
    ds_write_b16 v28, v120
    ds_write_b16_d16_hi v28, v120 offset:272
    ds_write_b16 v28, v121 offset:544
    ds_write_b16_d16_hi v28, v121 offset:816
    v_cvt_pk_bf16_f32 v122, v44, v45
    v_cvt_pk_bf16_f32 v123, v46, v47
    ds_write_b16 v29, v122
    ds_write_b16_d16_hi v29, v122 offset:272
    ds_write_b16 v29, v123 offset:544
    ds_write_b16_d16_hi v29, v123 offset:816
    s_waitcnt lgkmcnt(0)
    s_barrier
    ds_read_b128 v[116:119], v30 offset:0
    ds_read_b128 v[120:123], v30 offset:1088
    s_lshl_b32 s4, s60, 8
    s_lshl_b32 s5, s59, 3
    s_add_u32 s5, s5, s78
    s_lshl_b32 s5, s5, 12
    s_add_u32 s4, s4, s5
    s_waitcnt lgkmcnt(0)
    buffer_store_dwordx4 v[116:119], v31, s[16:19], s4 offen sc1
    s_add_u32 s4, s4, 16384
    buffer_store_dwordx4 v[120:123], v31, s[16:19], s4 offen sc1
L_recurrent_scan__spectral_fnet__mixer_gmlp__prompt_ts_39:
    s_waitcnt lgkmcnt(0)
    s_barrier
    v_fma_f32 v48, -v80, v100, v48
    v_fma_f32 v49, -v80, v101, v49
    v_fma_f32 v50, -v80, v102, v50
    v_fma_f32 v51, -v80, v103, v51
    v_fma_f32 v52, -v80, v104, v52
    v_fma_f32 v53, -v80, v105, v53
    v_fma_f32 v54, -v80, v106, v54
    v_fma_f32 v55, -v80, v107, v55
    v_fma_f32 v56, -v80, v108, v56
    v_fma_f32 v57, -v80, v109, v57
    v_fma_f32 v58, -v80, v110, v58
    v_fma_f32 v59, -v80, v111, v59
    v_fma_f32 v60, -v80, v112, v60
    v_fma_f32 v61, -v80, v113, v61
    v_fma_f32 v62, -v80, v114, v62
    v_fma_f32 v63, -v80, v115, v63
    v_mul_f32 v48, v48, v81
    v_mul_f32 v49, v49, v81
    v_mul_f32 v50, v50, v81
    v_mul_f32 v51, v51, v81
    v_mul_f32 v52, v52, v81
    v_mul_f32 v53, v53, v81
    v_mul_f32 v54, v54, v81
    v_mul_f32 v55, v55, v81
    v_mul_f32 v56, v56, v81
    v_mul_f32 v57, v57, v81
    v_mul_f32 v58, v58, v81
    v_mul_f32 v59, v59, v81
    v_mul_f32 v60, v60, v81
    v_mul_f32 v61, v61, v81
    v_mul_f32 v62, v62, v81
    v_mul_f32 v63, v63, v81
    s_cmp_eq_u32 s75, 1
    s_cbranch_scc0 L_recurrent_scan__spectral_fnet__mixer_gmlp__prompt_e2_40_z1
    s_lshl_b32 s78, s77, 6
    s_add_u32 s78, s78, 2048
    v_cvt_pk_bf16_f32 v116, v48, v49
    v_cvt_pk_bf16_f32 v117, v50, v51
    ds_write_b16 v26, v116
    ds_write_b16_d16_hi v26, v116 offset:272
    ds_write_b16 v26, v117 offset:544
    ds_write_b16_d16_hi v26, v117 offset:816
    v_cvt_pk_bf16_f32 v118, v52, v53
    v_cvt_pk_bf16_f32 v119, v54, v55
    ds_write_b16 v27, v118
    ds_write_b16_d16_hi v27, v118 offset:272
    ds_write_b16 v27, v119 offset:544
    ds_write_b16_d16_hi v27, v119 offset:816
    v_cvt_pk_bf16_f32 v120, v56, v57
    v_cvt_pk_bf16_f32 v121, v58, v59
    ds_write_b16 v28, v120
    ds_write_b16_d16_hi v28, v120 offset:272
    ds_write_b16 v28, v121 offset:544
    ds_write_b16_d16_hi v28, v121 offset:816
    v_cvt_pk_bf16_f32 v122, v60, v61
    v_cvt_pk_bf16_f32 v123, v62, v63
    ds_write_b16 v29, v122
    ds_write_b16_d16_hi v29, v122 offset:272
    ds_write_b16 v29, v123 offset:544
    ds_write_b16_d16_hi v29, v123 offset:816
    s_waitcnt lgkmcnt(0)
    s_barrier
    ds_read_b128 v[116:119], v30 offset:0
    ds_read_b128 v[120:123], v30 offset:1088
    s_lshl_b32 s4, s60, 8
    s_lshl_b32 s5, s59, 3
    s_add_u32 s5, s5, s78
    s_lshl_b32 s5, s5, 12
    s_add_u32 s4, s4, s5
    s_waitcnt lgkmcnt(0)
    buffer_store_dwordx4 v[116:119], v31, s[16:19], s4 offen sc1
    s_add_u32 s4, s4, 16384
    buffer_store_dwordx4 v[120:123], v31, s[16:19], s4 offen sc1
L_recurrent_scan__spectral_fnet__mixer_gmlp__prompt_ts_41:
    s_waitcnt lgkmcnt(0)
    s_branch L_recurrent_scan__spectral_fnet__mixer_gmlp__prompt_e2_40_d
L_recurrent_scan__spectral_fnet__mixer_gmlp__prompt_e2_40_z1:
    v_lshrrev_b32 v10, 1, v2
    v_and_b32 v11, 7, v3
    v_xor_b32 v10, v10, v11
    v_and_b32 v11, 1, v2
    v_lshl_add_u32 v11, v11, 3, v15
    v_cvt_pk_bf16_f32 v116, v48, v49
    v_cvt_pk_bf16_f32 v117, v50, v51
    s_lshl_b32 s5, s64, 1
    v_xor_b32 v124, s5, v10
    v_lshl_add_u32 v124, v124, 4, v11
    ds_write_b64 v124, v[116:117]
    v_cvt_pk_bf16_f32 v118, v52, v53
    v_cvt_pk_bf16_f32 v119, v54, v55
    s_lshl_b32 s5, s65, 1
    v_xor_b32 v124, s5, v10
    v_lshl_add_u32 v124, v124, 4, v11
    ds_write_b64 v124, v[118:119]
    v_cvt_pk_bf16_f32 v120, v56, v57
    v_cvt_pk_bf16_f32 v121, v58, v59
    s_lshl_b32 s5, s66, 1
    v_xor_b32 v124, s5, v10
    v_lshl_add_u32 v124, v124, 4, v11
    ds_write_b64 v124, v[120:121]
    v_cvt_pk_bf16_f32 v122, v60, v61
    v_cvt_pk_bf16_f32 v123, v62, v63
    s_lshl_b32 s5, s67, 1
    v_xor_b32 v124, s5, v10
    v_lshl_add_u32 v124, v124, 4, v11
    ds_write_b64 v124, v[122:123]
    s_waitcnt lgkmcnt(0)
    ds_read_b128 v[116:119], v12 offset:0
    ds_read_b128 v[120:123], v12 offset:1024
    s_lshl_b32 s4, s60, 7
    s_lshl_b32 s5, s59, 4
    s_add_u32 s4, s4, s5
    s_mul_i32 s4, s4, 1408
    s_lshl_b32 s5, s77, 7
    s_add_u32 s4, s4, s5
    s_add_u32 s4, s4, 5242880
    s_waitcnt lgkmcnt(0)
    buffer_store_dwordx4 v[116:119], v13, s[16:19], s4 offen sc1
    s_add_u32 s4, s4, 11264
    buffer_store_dwordx4 v[120:123], v13, s[16:19], s4 offen sc1
    s_nop 1
L_recurrent_scan__spectral_fnet__mixer_gmlp__prompt_e2_40_d:
    s_waitcnt vmcnt(16)
    s_mul_i32 s5, s82, 0
    s_add_u32 s5, s5, s79
    v_xor_b32 v124, 0, v8
    v_add_u32 v124, s5, v124
    v_xor_b32 v125, 32, v8
    v_add_u32 v125, s5, v125
    v_xor_b32 v126, 64, v8
    v_add_u32 v126, s5, v126
    v_xor_b32 v127, 96, v8
    v_add_u32 v127, s5, v127
    ds_read_b128 a[0:3], v124
    ds_read_b128 a[4:7], v125
    ds_read_b128 a[8:11], v126
    ds_read_b128 a[12:15], v127
    s_waitcnt vmcnt(12)
    s_mul_i32 s5, s82, 1
    s_add_u32 s5, s5, s79
    v_xor_b32 v124, 0, v8
    v_add_u32 v124, s5, v124
    v_xor_b32 v125, 32, v8
    v_add_u32 v125, s5, v125
    v_xor_b32 v126, 64, v8
    v_add_u32 v126, s5, v126
    v_xor_b32 v127, 96, v8
    v_add_u32 v127, s5, v127
    ds_read_b128 a[16:19], v124
    ds_read_b128 a[20:23], v125
    ds_read_b128 a[24:27], v126
    ds_read_b128 a[28:31], v127
    s_waitcnt vmcnt(8)
    s_mul_i32 s5, s82, 2
    s_add_u32 s5, s5, s79
    v_xor_b32 v124, 0, v8
    v_add_u32 v124, s5, v124
    v_xor_b32 v125, 32, v8
    v_add_u32 v125, s5, v125
    v_xor_b32 v126, 64, v8
    v_add_u32 v126, s5, v126
    v_xor_b32 v127, 96, v8
    v_add_u32 v127, s5, v127
    ds_read_b128 a[32:35], v124
    ds_read_b128 a[36:39], v125
    ds_read_b128 a[40:43], v126
    ds_read_b128 a[44:47], v127
    s_waitcnt vmcnt(4)
    s_mul_i32 s5, s82, 3
    s_add_u32 s5, s5, s79
    v_xor_b32 v124, 0, v8
    v_add_u32 v124, s5, v124
    v_xor_b32 v125, 32, v8
    v_add_u32 v125, s5, v125
    v_xor_b32 v126, 64, v8
    v_add_u32 v126, s5, v126
    v_xor_b32 v127, 96, v8
    v_add_u32 v127, s5, v127
    ds_read_b128 a[48:51], v124
    ds_read_b128 a[52:55], v125
    ds_read_b128 a[56:59], v126
    ds_read_b128 a[60:63], v127
    s_waitcnt lgkmcnt(0)
    s_mul_i32 s5, s82, 0
    s_add_u32 m0, s5, s79
    s_nop 0
    buffer_load_dwordx4 v6, s[24:27], s83 offen lds
    buffer_load_dwordx4 v7, s[24:27], s83 offen offset:1024 lds
    s_add_u32 s5, s83, 63488
    buffer_load_dwordx4 v6, s[24:27], s5 offen offset:2048 lds
    buffer_load_dwordx4 v7, s[24:27], s5 offen offset:3072 lds
    s_add_u32 s83, s83, 128
    s_mul_i32 s5, s82, 1
    s_add_u32 m0, s5, s79
    s_nop 0
    buffer_load_dwordx4 v6, s[24:27], s83 offen lds
    buffer_load_dwordx4 v7, s[24:27], s83 offen offset:1024 lds
    s_add_u32 s5, s83, 63488
    buffer_load_dwordx4 v6, s[24:27], s5 offen offset:2048 lds
    buffer_load_dwordx4 v7, s[24:27], s5 offen offset:3072 lds
    s_add_u32 s83, s83, 128
    s_cmp_lt_u32 s59, 4
    s_cbranch_scc0 L_recurrent_scan__spectral_fnet__mixer_gmlp__prompt_fc_42
    s_lshl_b32 s4, s59, 4
    v_add_u32 v10, s4, v3
    v_lshlrev_b32 v11, 2, v2
    v_add_u32 v103, 0, v11
    v_mul_u32_u24 v103, v103, v10
    v_cvt_f32_u32 v103, v103
    v_mul_f32 v103, 973078528, v103
    v_cos_f32 v16, v103
    v_sin_f32 v24, v103
    v_add_u32 v103, 1, v11
    v_mul_u32_u24 v103, v103, v10
    v_cvt_f32_u32 v103, v103
    v_mul_f32 v103, 973078528, v103
    v_cos_f32 v17, v103
    v_sin_f32 v25, v103
    v_add_u32 v103, 2, v11
    v_mul_u32_u24 v103, v103, v10
    v_cvt_f32_u32 v103, v103
    v_mul_f32 v103, 973078528, v103
    v_cos_f32 v18, v103
    v_sin_f32 v79, v103
    v_add_u32 v103, 3, v11
    v_mul_u32_u24 v103, v103, v10
    v_cvt_f32_u32 v103, v103
    v_mul_f32 v103, 973078528, v103
    v_cos_f32 v19, v103
    v_sin_f32 v82, v103
    v_add_u32 v103, 16, v11
    v_mul_u32_u24 v103, v103, v10
    v_cvt_f32_u32 v103, v103
    v_mul_f32 v103, 973078528, v103
    v_cos_f32 v20, v103
    v_sin_f32 v83, v103
    v_add_u32 v103, 17, v11
    v_mul_u32_u24 v103, v103, v10
    v_cvt_f32_u32 v103, v103
    v_mul_f32 v103, 973078528, v103
    v_cos_f32 v21, v103
    v_sin_f32 v100, v103
    v_add_u32 v103, 18, v11
    v_mul_u32_u24 v103, v103, v10
    v_cvt_f32_u32 v103, v103
    v_mul_f32 v103, 973078528, v103
    v_cos_f32 v22, v103
    v_sin_f32 v101, v103
    v_add_u32 v103, 19, v11
    v_mul_u32_u24 v103, v103, v10
    v_cvt_f32_u32 v103, v103
    v_mul_f32 v103, 973078528, v103
    v_cos_f32 v23, v103
    v_sin_f32 v102, v103
    v_lshrrev_b32 v11, 2, v3
    v_lshl_add_u32 v11, v2, 3, v11
    v_lshlrev_b32 v11, 6, v11
    v_and_b32 v103, 3, v3
    v_lshl_add_u32 v11, v103, 3, v11
    v_add_u32 v76, 147456, v11
    s_lshl_b32 s4, s59, 4
    v_lshlrev_b32 v11, 2, v2
    v_add_u32 v11, s4, v11
    v_lshl_add_u32 v78, v3, 6, v11
    v_lshlrev_b32 v11, 1, v78
    v_add_u32 v77, 155648, v11
L_recurrent_scan__spectral_fnet__mixer_gmlp__prompt_fc_42:
    s_lshr_b32 s66, s59, 2
    s_and_b32 s67, s59, 3
    v_and_b32 v10, 7, v1
    v_lshrrev_b32 v11, 4, v1
    v_xor_b32 v10, v10, v11
    v_lshrrev_b32 v11, 3, v1
    v_lshlrev_b32 v12, 12, v11
    v_lshl_add_u32 v13, v10, 4, v12
    v_xor_b32 v10, 4, v10
    v_lshl_add_u32 v14, v10, 4, v12
    v_add_u32 v104, 0, v13
    v_add_u32 v105, 31744, v14
    v_add_u32 v106, 63488, v13
    v_add_u32 v107, 95232, v14
    v_add_u32 v108, 131072, v13
    v_add_u32 v109, 162816, v14
    s_mul_i32 s4, s63, 96
    s_mul_i32 s5, s66, 48
    s_add_u32 s4, s4, s5
    s_lshl_b32 s4, s4, 12
    s_lshl_b32 s5, s67, 10
    s_add_u32 s64, s4, s5
    s_mul_i32 s4, s67, 12288
    s_mul_i32 s5, s66, 6144
    s_add_u32 s65, s4, s5
    v_and_b32 v10, 31, v1
    v_lshrrev_b32 v11, 1, v10
    v_and_b32 v11, 7, v11
    v_lshrrev_b32 v12, 5, v1
    v_xor_b32 v11, v11, v12
    v_lshlrev_b32 v10, 7, v10
    v_lshl_add_u32 v10, v11, 4, v10
    v_xor_b32 v110, 0, v10
    v_add_u32 v110, s4, v110
    v_xor_b32 v111, 32, v10
    v_add_u32 v111, s4, v111
    v_xor_b32 v112, 64, v10
    v_add_u32 v112, s4, v112
    v_xor_b32 v113, 96, v10
    v_add_u32 v113, s4, v113
    s_mul_i32 s4, s63, 96
    s_add_u32 s5, s4, 48
    s_lshr_b32 s5, s5, 6
    v_lshrrev_b32 v10, 4, v1
    v_add_u32 v10, s5, v10
    v_min_u32 v10, 11, v10
    v_and_b32 v11, 15, v1
    v_lshl_add_u32 v10, v10, 4, v11
    v_lshlrev_b32 v10, 7, v10
    v_add_u32 v10, 4096, v10
    s_lshr_b32 s4, s4, 6
    s_sub_u32 s4, s4, 48
    v_add_u32 v11, s4, v1
    v_min_u32 v11, 10, v11
    s_lshr_b32 s5, s62, 1
    v_lshlrev_b32 v11, 4, v11
    v_add_u32 v11, s5, v11
    v_lshlrev_b32 v11, 7, v11
    v_add_u32 v11, 53248, v11
    v_cmp_lt_u32 vcc, 47, v1
    s_nop 1
    v_cndmask_b32 v114, v10, v11, vcc
    s_lshr_b32 s4, s2, 6
    s_cmp_eq_u32 s2, 0
    s_cselect_b32 s5, 4, s4
    s_add_u32 s4, s4, 5
    v_mov_b32 v115, s5
    v_mov_b32 v11, s4
    v_and_b32 v13, 31, v1
    v_cmp_lt_u32 vcc, 15, v13
    s_nop 1
    v_cndmask_b32 v115, v115, v11, vcc
    v_lshlrev_b32 v115, 4, v115
    v_add_u32 v115, v115, v3
    v_lshlrev_b32 v115, 7, v115
    v_add_u32 v115, 32768, v115
    s_waitcnt vmcnt(8)
    s_barrier
    s_cmp_eq_u32 s74, 0
    s_cselect_b32 s6, s61, s76
    s_mov_b32 s5, 32768
    s_cselect_b32 s5, 4096, s5
    s_lshl_b32 s6, s6, 4
    s_add_u32 s6, s6, s60
    s_lshl_b32 s6, s6, 7
    s_add_u32 s6, s6, s5
    s_cmp_lg_u32 s59, 0
    s_cbranch_scc1 L_recurrent_scan__spectral_fnet__mixer_gmlp__prompt_fl_43
    v_mov_b32 v10, s58
    v_mov_b32 v11, s6
    s_mov_b64 exec, 1
    buffer_store_dword v10, v11, s[16:19], 0 offen sc1
    s_mov_b64 exec, -1
L_recurrent_scan__spectral_fnet__mixer_gmlp__prompt_fl_43:
    s_cmp_eq_u32 s75, 1
    s_mov_b32 s6, s77
    s_mov_b32 s5, 53248
    s_cselect_b32 s5, 32768, s5
    s_lshl_b32 s6, s6, 4
    s_add_u32 s6, s6, s60
    s_lshl_b32 s6, s6, 7
    s_add_u32 s6, s6, s5
    s_cmp_lg_u32 s59, 7
    s_cbranch_scc1 L_recurrent_scan__spectral_fnet__mixer_gmlp__prompt_fl_44
    v_mov_b32 v10, s58
    v_mov_b32 v11, s6
    s_mov_b64 exec, 1
    buffer_store_dword v10, v11, s[16:19], 0 offen sc1
    s_mov_b64 exec, -1
L_recurrent_scan__spectral_fnet__mixer_gmlp__prompt_fl_44:
    s_waitcnt vmcnt(0)
L_recurrent_scan__spectral_fnet__mixer_gmlp__prompt_e1_27_d:
    s_cmp_lg_u32 s59, 0
    s_cbranch_scc1 L_recurrent_scan__spectral_fnet__mixer_gmlp__prompt_pw_45_d
    s_mov_b32 s6, 0
L_recurrent_scan__spectral_fnet__mixer_gmlp__prompt_pw_45:
    buffer_load_dword v11, v115, s[16:19], 0 offen sc1
    s_waitcnt vmcnt(0)
    v_cmp_ne_u32 vcc, s58, v11
    s_add_u32 s6, s6, 1
    s_cmp_gt_u32 s6, 200000
    s_cbranch_scc1 L_recurrent_scan__spectral_fnet__mixer_gmlp__prompt_pw_45_d
    s_cbranch_vccnz L_recurrent_scan__spectral_fnet__mixer_gmlp__prompt_pw_45
L_recurrent_scan__spectral_fnet__mixer_gmlp__prompt_pw_45_d:
    s_barrier
    s_cmp_eq_u32 s2, 0
    s_cselect_b32 s4, 256, s2
    s_add_u32 s5, s2, 320
    s_cmp_lt_u32 s59, 4
    s_cselect_b32 s4, s4, s5
    s_lshl_b32 s4, s4, 12
    s_and_b32 s5, s59, 3
    s_lshl_b32 s5, s5, 10
    s_add_u32 s4, s4, s5
    s_add_u32 s4, s4, 8388608
    s_lshl_b32 s5, s59, 10
    s_add_u32 m0, s5, 147456
    v_lshlrev_b32 v10, 4, v1
    buffer_load_dwordx4 v10, s[16:19], s4 offen lds
    v_and_b32 v10, 7, v1
    v_xor_b32 v10, v10, v2
    s_and_b32 s4, s59, 1
    s_lshl_b32 s4, s4, 2
    v_xor_b32 v10, s4, v10
    v_lshrrev_b32 v11, 3, v1
    v_lshlrev_b32 v11, 13, v11
    v_lshl_add_u32 v10, v10, 4, v11
    s_lshl_b32 s4, s59, 16
    s_lshl_b32 s5, s59, 10
    s_add_u32 m0, s5, 131072
    s_nop 0
    buffer_load_dwordx4 v10, s[36:39], s4 offen lds
    s_add_u32 m0, s5, 139264
    s_nop 0
    buffer_load_dwordx4 v10, s[40:43], s4 offen lds
    s_mul_i32 s5, s82, 2
    s_add_u32 m0, s5, s79
    s_nop 0
    buffer_load_dwordx4 v6, s[24:27], s83 offen lds
    buffer_load_dwordx4 v7, s[24:27], s83 offen offset:1024 lds
    s_add_u32 s5, s83, 63488
    buffer_load_dwordx4 v6, s[24:27], s5 offen offset:2048 lds
    buffer_load_dwordx4 v7, s[24:27], s5 offen offset:3072 lds
    s_add_u32 s83, s83, 128
    s_mul_i32 s5, s82, 3
    s_add_u32 m0, s5, s79
    s_nop 0
    buffer_load_dwordx4 v6, s[24:27], s83 offen lds
    buffer_load_dwordx4 v7, s[24:27], s83 offen offset:1024 lds
    s_add_u32 s5, s83, 63488
    buffer_load_dwordx4 v6, s[24:27], s5 offen offset:2048 lds
    buffer_load_dwordx4 v7, s[24:27], s5 offen offset:3072 lds
    s_add_u32 s83, s83, 128
    s_waitcnt vmcnt(15)
    s_mul_i32 s5, s82, 0
    s_add_u32 s5, s5, s79
    v_xor_b32 v12, 0, v8
    v_add_u32 v12, s5, v12
    v_xor_b32 v13, 32, v8
    v_add_u32 v13, s5, v13
    v_xor_b32 v14, 64, v8
    v_add_u32 v14, s5, v14
    v_xor_b32 v15, 96, v8
    v_add_u32 v15, s5, v15
    ds_read_b128 a[64:67], v12
    ds_read_b128 a[68:71], v13
    ds_read_b128 a[72:75], v14
    ds_read_b128 a[76:79], v15
    s_waitcnt vmcnt(11)
    s_mul_i32 s5, s82, 1
    s_add_u32 s5, s5, s79
    v_xor_b32 v12, 0, v8
    v_add_u32 v12, s5, v12
    v_xor_b32 v13, 32, v8
    v_add_u32 v13, s5, v13
    v_xor_b32 v14, 64, v8
    v_add_u32 v14, s5, v14
    v_xor_b32 v15, 96, v8
    v_add_u32 v15, s5, v15
    ds_read_b128 a[80:83], v12
    ds_read_b128 a[84:87], v13
    ds_read_b128 a[88:91], v14
    ds_read_b128 a[92:95], v15
    s_cmp_lg_u32 s59, 0
    s_cbranch_scc1 L_recurrent_scan__spectral_fnet__mixer_gmlp__prompt_pw_46_d
    s_mov_b32 s6, 0
L_recurrent_scan__spectral_fnet__mixer_gmlp__prompt_pw_46:
    buffer_load_dword v11, v114, s[16:19], 0 offen sc1
    s_waitcnt vmcnt(0)
    v_cmp_ne_u32 vcc, s58, v11
    s_add_u32 s6, s6, 1
    s_cmp_gt_u32 s6, 200000
    s_cbranch_scc1 L_recurrent_scan__spectral_fnet__mixer_gmlp__prompt_pw_46_d
    s_cbranch_vccnz L_recurrent_scan__spectral_fnet__mixer_gmlp__prompt_pw_46
L_recurrent_scan__spectral_fnet__mixer_gmlp__prompt_pw_46_d:
    s_waitcnt vmcnt(0)
    s_waitcnt vmcnt(4)
    s_mul_i32 s5, s82, 2
    s_add_u32 s5, s5, s79
    v_xor_b32 v12, 0, v8
    v_add_u32 v12, s5, v12
    v_xor_b32 v13, 32, v8
    v_add_u32 v13, s5, v13
    v_xor_b32 v14, 64, v8
    v_add_u32 v14, s5, v14
    v_xor_b32 v15, 96, v8
    v_add_u32 v15, s5, v15
    ds_read_b128 a[96:99], v12
    ds_read_b128 a[100:103], v13
    ds_read_b128 a[104:107], v14
    ds_read_b128 a[108:111], v15
    s_waitcnt vmcnt(0)
    s_mul_i32 s5, s82, 3
    s_add_u32 s5, s5, s79
    v_xor_b32 v12, 0, v8
    v_add_u32 v12, s5, v12
    v_xor_b32 v13, 32, v8
    v_add_u32 v13, s5, v13
    v_xor_b32 v14, 64, v8
    v_add_u32 v14, s5, v14
    v_xor_b32 v15, 96, v8
    v_add_u32 v15, s5, v15
    ds_read_b128 a[112:115], v12
    ds_read_b128 a[116:119], v13
    ds_read_b128 a[120:123], v14
    ds_read_b128 a[124:127], v15
    s_waitcnt lgkmcnt(0)
    s_barrier
    s_cmp_eq_u32 s66, 1
    s_cbranch_scc0 L_recurrent_scan__spectral_fnet__mixer_gmlp__prompt_bi_47
    s_add_u32 s4, s64, 4294770688
    s_add_u32 s5, s65, 4294961152
    s_add_u32 m0, s5, 0
    s_nop 0
    buffer_load_dwordx4 v104, s[20:23], s4 offen offset:0 lds
    buffer_load_dwordx4 v105, s[20:23], s4 offen offset:1024 lds
    buffer_load_dwordx4 v106, s[20:23], s4 offen offset:2048 lds
    buffer_load_dwordx4 v107, s[20:23], s4 offen offset:3072 lds
    s_add_u32 m0, s5, 4096
    s_nop 0
    buffer_load_dwordx4 v108, s[20:23], s4 offen offset:0 lds
    buffer_load_dwordx4 v109, s[20:23], s4 offen offset:1024 lds
    s_add_u32 s4, s64, 0
    s_add_u32 s5, s65, 0
    s_add_u32 m0, s5, 0
    s_nop 0
    buffer_load_dwordx4 v104, s[20:23], s4 offen offset:0 lds
    buffer_load_dwordx4 v105, s[20:23], s4 offen offset:1024 lds
    buffer_load_dwordx4 v106, s[20:23], s4 offen offset:2048 lds
    buffer_load_dwordx4 v107, s[20:23], s4 offen offset:3072 lds
    s_add_u32 m0, s5, 4096
    s_nop 0
    buffer_load_dwordx4 v108, s[20:23], s4 offen offset:0 lds
    buffer_load_dwordx4 v109, s[20:23], s4 offen offset:1024 lds
L_recurrent_scan__spectral_fnet__mixer_gmlp__prompt_bi_47:
    s_add_u32 s64, s64, 128
    s_cmp_lt_u32 s59, 4
    s_cbranch_scc0 L_recurrent_scan__spectral_fnet__mixer_gmlp__prompt_fft_48_skip
    s_lshl_b32 s4, s59, 4
    v_add_u32 v10, s4, v3
    v_lshrrev_b32 v11, 1, v10
    v_and_b32 v11, 7, v11
    v_xor_b32 v11, v11, v2
    v_lshlrev_b32 v10, 7, v10
    v_lshl_add_u32 v12, v11, 4, v10
    v_add_u32 v12, 131072, v12
    v_xor_b32 v13, 64, v12
    ds_read_b128 v[44:47], v12
    ds_read_b128 v[48:51], v13
    ds_read_b128 v[52:55], v12 offset:8192
    ds_read_b128 v[56:59], v13 offset:8192
    v_lshrrev_b32 v10, 1, v2
    v_and_b32 v11, 7, v3
    v_xor_b32 v10, v10, v11
    v_lshlrev_b32 v11, 8, v3
    v_lshl_add_u32 v10, v10, 4, v11
    v_and_b32 v11, 1, v2
    v_lshl_add_u32 v10, v11, 3, v10
    v_add_u32 v10, 131072, v10
    v_xor_b32 v11, 32, v10
    ds_read_b64 v[60:61], v10 offset:0
    ds_read_b64 v[62:63], v11 offset:0
    ds_read_b64 v[68:69], v10 offset:8192
    ds_read_b64 v[70:71], v11 offset:8192
    ds_read_b64 v[64:65], v10 offset:4096
    ds_read_b64 v[66:67], v11 offset:4096
    ds_read_b64 v[72:73], v10 offset:12288
    ds_read_b64 v[74:75], v11 offset:12288
    s_waitcnt lgkmcnt(8)
    v_xor_b32 v40, 0x80008000, v52
    v_xor_b32 v41, 0x80008000, v53
    v_xor_b32 v42, 0x80008000, v54
    v_xor_b32 v43, 0x80008000, v55
    v_xor_b32 v26, 0x80008000, v56
    v_xor_b32 v27, 0x80008000, v57
    v_xor_b32 v28, 0x80008000, v58
    v_xor_b32 v29, 0x80008000, v59
    ds_read_b64_tr_b16 v[84:85], v76 offset:0
    ds_read_b64_tr_b16 v[86:87], v76 offset:256
    ds_read_b64_tr_b16 v[88:89], v76 offset:2048
    ds_read_b64_tr_b16 v[90:91], v76 offset:2304
    ds_read_b64_tr_b16 v[92:93], v76 offset:4096
    ds_read_b64_tr_b16 v[94:95], v76 offset:4352
    ds_read_b64_tr_b16 v[96:97], v76 offset:6144
    ds_read_b64_tr_b16 v[98:99], v76 offset:6400
    s_waitcnt lgkmcnt(0)
    v_mfma_f32_16x16x32_bf16 v[32:35], v[84:87], v[44:47], 0
    v_mfma_f32_16x16x32_bf16 v[116:119], v[92:95], v[44:47], 0
    v_mfma_f32_16x16x32_bf16 v[32:35], v[88:91], v[48:51], v[32:35]
    v_mfma_f32_16x16x32_bf16 v[116:119], v[96:99], v[48:51], v[116:119]
    v_mfma_f32_16x16x32_bf16 v[32:35], v[92:95], v[40:43], v[32:35]
    v_mfma_f32_16x16x32_bf16 v[116:119], v[84:87], v[52:55], v[116:119]
    v_mfma_f32_16x16x32_bf16 v[32:35], v[96:99], v[26:29], v[32:35]
    v_mfma_f32_16x16x32_bf16 v[116:119], v[88:91], v[56:59], v[116:119]
    ds_read_b64_tr_b16 v[84:85], v76 offset:32
    ds_read_b64_tr_b16 v[86:87], v76 offset:288
    ds_read_b64_tr_b16 v[88:89], v76 offset:2080
    ds_read_b64_tr_b16 v[90:91], v76 offset:2336
    ds_read_b64_tr_b16 v[92:93], v76 offset:4128
    ds_read_b64_tr_b16 v[94:95], v76 offset:4384
    ds_read_b64_tr_b16 v[96:97], v76 offset:6176
    ds_read_b64_tr_b16 v[98:99], v76 offset:6432
    s_waitcnt lgkmcnt(0)
    v_mfma_f32_16x16x32_bf16 v[36:39], v[84:87], v[44:47], 0
    v_mfma_f32_16x16x32_bf16 v[120:123], v[92:95], v[44:47], 0
    v_mfma_f32_16x16x32_bf16 v[36:39], v[88:91], v[48:51], v[36:39]
    v_mfma_f32_16x16x32_bf16 v[120:123], v[96:99], v[48:51], v[120:123]
    v_mfma_f32_16x16x32_bf16 v[36:39], v[92:95], v[40:43], v[36:39]
    v_mfma_f32_16x16x32_bf16 v[120:123], v[84:87], v[52:55], v[120:123]
    v_mfma_f32_16x16x32_bf16 v[36:39], v[96:99], v[26:29], v[36:39]
    v_mfma_f32_16x16x32_bf16 v[120:123], v[88:91], v[56:59], v[120:123]
    v_mul_f32 v84, v32, v16
    v_mul_f32 v92, v32, v24
    v_mul_f32 v85, v33, v17
    v_mul_f32 v93, v33, v25
    v_mul_f32 v86, v34, v18
    v_mul_f32 v94, v34, v79
    v_mul_f32 v87, v35, v19
    v_mul_f32 v95, v35, v82
    v_mul_f32 v88, v36, v20
    v_mul_f32 v96, v36, v83
    v_mul_f32 v89, v37, v21
    v_mul_f32 v97, v37, v100
    v_mul_f32 v90, v38, v22
    v_mul_f32 v98, v38, v101
    v_mul_f32 v91, v39, v23
    v_mul_f32 v99, v39, v102
    v_fma_f32 v84, v116, v24, v84
    v_fma_f32 v92, -v116, v16, v92
    v_fma_f32 v85, v117, v25, v85
    v_fma_f32 v93, -v117, v17, v93
    v_fma_f32 v86, v118, v79, v86
    v_fma_f32 v94, -v118, v18, v94
    v_fma_f32 v87, v119, v82, v87
    v_fma_f32 v95, -v119, v19, v95
    v_fma_f32 v88, v120, v83, v88
    v_fma_f32 v96, -v120, v20, v96
    v_fma_f32 v89, v121, v100, v89
    v_fma_f32 v97, -v121, v21, v97
    v_fma_f32 v90, v122, v101, v90
    v_fma_f32 v98, -v122, v22, v98
    v_fma_f32 v91, v123, v102, v91
    v_fma_f32 v99, -v123, v23, v99
    v_cvt_pk_bf16_f32 v32, v84, v85
    v_cvt_pk_bf16_f32 v33, v86, v87
    v_cvt_pk_bf16_f32 v34, v88, v89
    v_cvt_pk_bf16_f32 v35, v90, v91
    v_cvt_pk_bf16_f32 v36, v92, v93
    v_cvt_pk_bf16_f32 v37, v94, v95
    v_cvt_pk_bf16_f32 v38, v96, v97
    v_cvt_pk_bf16_f32 v39, v98, v99
    v_mfma_f32_16x16x32_bf16 v[116:119], v[32:35], v[60:63], 0
    v_mfma_f32_16x16x32_bf16 v[120:123], v[32:35], v[64:67], 0
    v_mfma_f32_16x16x32_bf16 v[116:119], v[36:39], v[68:71], v[116:119]
    v_mfma_f32_16x16x32_bf16 v[120:123], v[36:39], v[72:75], v[120:123]
    v_sub_u32 v84, 2048, v78
    v_and_b32 v84, 2047, v84
    v_lshlrev_b32 v84, 1, v84
    v_add_u32 v84, 159744, v84
    v_sub_u32 v85, 2047, v78
    v_and_b32 v85, 2047, v85
    v_lshlrev_b32 v85, 1, v85
    v_add_u32 v85, 159744, v85
    v_sub_u32 v86, 2046, v78
    v_and_b32 v86, 2047, v86
    v_lshlrev_b32 v86, 1, v86
    v_add_u32 v86, 159744, v86
    v_sub_u32 v87, 2045, v78
    v_and_b32 v87, 2047, v87
    v_lshlrev_b32 v87, 1, v87
    v_add_u32 v87, 159744, v87
    v_sub_u32 v88, 1024, v78
    v_and_b32 v88, 2047, v88
    v_lshlrev_b32 v88, 1, v88
    v_add_u32 v88, 159744, v88
    v_sub_u32 v89, 1023, v78
    v_and_b32 v89, 2047, v89
    v_lshlrev_b32 v89, 1, v89
    v_add_u32 v89, 159744, v89
    v_sub_u32 v90, 1022, v78
    v_and_b32 v90, 2047, v90
    v_lshlrev_b32 v90, 1, v90
    v_add_u32 v90, 159744, v90
    v_sub_u32 v91, 1021, v78
    v_and_b32 v91, 2047, v91
    v_lshlrev_b32 v91, 1, v91
    v_add_u32 v91, 159744, v91
    v_cvt_pk_bf16_f32 v92, v116, v117
    v_cvt_pk_bf16_f32 v93, v118, v119
    ds_write_b64 v77, v[92:93] offset:0
    ds_write_b16 v84, v92
    ds_write_b16_d16_hi v85, v92
    ds_write_b16 v86, v93
    ds_write_b16_d16_hi v87, v93
    v_cvt_pk_bf16_f32 v94, v120, v121
    v_cvt_pk_bf16_f32 v95, v122, v123
    ds_write_b64 v77, v[94:95] offset:2048
    ds_write_b16 v88, v94
    ds_write_b16_d16_hi v89, v94
    ds_write_b16 v90, v95
    ds_write_b16_d16_hi v91, v95
L_recurrent_scan__spectral_fnet__mixer_gmlp__prompt_fft_48_skip:
    v_lshlrev_b32 v10, 4, v1
    s_lshl_b32 s5, s59, 10
    s_add_u32 s5, s5, 155648
    v_add_u32 v11, s5, v10
    s_waitcnt lgkmcnt(0)
    s_barrier
    ds_read_b128 v[22:25], v11
    s_waitcnt lgkmcnt(0)
    s_cmp_lg_u32 s2, 0
    s_cbranch_scc1 L_recurrent_scan__spectral_fnet__mixer_gmlp__prompt_fz_49
    s_cmp_lt_u32 s59, 4
    s_cbranch_scc1 L_recurrent_scan__spectral_fnet__mixer_gmlp__prompt_fz_49
    v_mov_b32 v22, 0
    v_mov_b32 v23, 0
    v_mov_b32 v24, 0
    v_mov_b32 v25, 0
L_recurrent_scan__spectral_fnet__mixer_gmlp__prompt_fz_49:
    s_cmp_eq_u32 s66, 0
    s_cbranch_scc0 L_recurrent_scan__spectral_fnet__mixer_gmlp__prompt_bi_50
    s_add_u32 s4, s64, 0
    s_add_u32 s5, s65, 0
    s_add_u32 m0, s5, 49152
    s_nop 0
    buffer_load_dwordx4 v104, s[20:23], s4 offen offset:0 lds
    buffer_load_dwordx4 v105, s[20:23], s4 offen offset:1024 lds
    buffer_load_dwordx4 v106, s[20:23], s4 offen offset:2048 lds
    buffer_load_dwordx4 v107, s[20:23], s4 offen offset:3072 lds
    s_add_u32 m0, s5, 53248
    s_nop 0
    buffer_load_dwordx4 v108, s[20:23], s4 offen offset:0 lds
    buffer_load_dwordx4 v109, s[20:23], s4 offen offset:1024 lds
    s_add_u32 s4, s64, 196608
    s_add_u32 s5, s65, 6144
    s_add_u32 m0, s5, 49152
    s_nop 0
    buffer_load_dwordx4 v104, s[20:23], s4 offen offset:0 lds
    buffer_load_dwordx4 v105, s[20:23], s4 offen offset:1024 lds
    buffer_load_dwordx4 v106, s[20:23], s4 offen offset:2048 lds
    buffer_load_dwordx4 v107, s[20:23], s4 offen offset:3072 lds
    s_add_u32 m0, s5, 53248
    s_nop 0
    buffer_load_dwordx4 v108, s[20:23], s4 offen offset:0 lds
    buffer_load_dwordx4 v109, s[20:23], s4 offen offset:1024 lds
L_recurrent_scan__spectral_fnet__mixer_gmlp__prompt_bi_50:
    s_add_u32 s64, s64, 128
    s_cmp_eq_u32 s66, 1
    s_cbranch_scc0 L_recurrent_scan__spectral_fnet__mixer_gmlp__prompt_t0_51
    s_waitcnt vmcnt(0)
L_recurrent_scan__spectral_fnet__mixer_gmlp__prompt_t0_51:
    s_barrier
    ds_read_b128 v[80:83], v110 offset:0
    ds_read_b128 v[84:87], v110 offset:4096
    ds_read_b128 v[88:91], v110 offset:8192
    s_waitcnt lgkmcnt(0)
    v_mfma_f32_32x32x16_bf16 v[32:47], v[80:83], a[0:3], 0
    ds_read_b128 v[92:95], v111 offset:0
    ds_read_b128 v[96:99], v111 offset:4096
    ds_read_b128 v[100:103], v111 offset:8192
    s_cmp_eq_u32 s66, 0
    s_cbranch_scc0 L_recurrent_scan__spectral_fnet__mixer_gmlp__prompt_st_52
    s_add_u32 m0, s65, 98304
    s_nop 0
    buffer_load_dwordx4 v104, s[20:23], s64 offen offset:0 lds
    buffer_load_dwordx4 v105, s[20:23], s64 offen offset:1024 lds
    buffer_load_dwordx4 v106, s[20:23], s64 offen offset:2048 lds
    buffer_load_dwordx4 v107, s[20:23], s64 offen offset:3072 lds
    s_add_u32 m0, s65, 102400
    s_nop 0
    buffer_load_dwordx4 v108, s[20:23], s64 offen offset:0 lds
    buffer_load_dwordx4 v109, s[20:23], s64 offen offset:1024 lds
    s_add_u32 s64, s64, 128
    v_and_b32 v10, 15, v1
    v_lshrrev_b32 v11, 4, v1
    s_lshl_b32 s4, s59, 3
    v_add_u32 v11, s4, v11
    v_and_b32 v12, 15, v11
    v_xor_b32 v12, v12, v10
    v_subrev_u32 v13, 4, v12
    v_cmp_lt_u32 vcc, 11, v12
    s_nop 1
    v_cndmask_b32 v12, v12, v13, vcc
    v_xor_b32 v14, 4, v11
    v_add_u32 v14, 4, v11
    v_and_b32 v14, 15, v14
    v_xor_b32 v14, v14, v10
    v_subrev_u32 v13, 4, v14
    v_cmp_lt_u32 vcc, 11, v14
    s_nop 1
    v_cndmask_b32 v14, v14, v13, vcc
    s_mov_b32 s7, 1408
    v_mul_lo_u32 v11, v11, s7
    v_lshl_add_u32 v12, v12, 4, v11
    v_lshl_add_u32 v14, v14, 4, v11
    v_add_u32 v14, 4608, v14
    s_lshl_b32 s4, s62, 6
    s_mul_i32 s4, s4, 1408
    s_mul_i32 s5, s63, 192
    s_add_u32 s4, s4, s5
    s_add_u32 s4, s4, 5242880
    s_lshl_b32 s5, s59, 11
    s_add_u32 m0, s5, 147456
    s_nop 0
    buffer_load_dwordx4 v12, s[16:19], s4 offen lds
    buffer_load_dwordx4 v14, s[16:19], s4 offen offset:1024 lds
    s_lshl_b32 s4, s62, 6
    s_lshl_b32 s5, s66, 5
    s_add_u32 s4, s4, s5
    v_and_b32 v10, 31, v1
    v_add_u32 v10, s4, v10
    v_lshlrev_b32 v11, 1, v10
    s_mov_b32 s44, s54
    s_mov_b32 s45, s55
    s_mov_b32 s46, 4096
    s_mov_b32 s47, 0x00020000
    buffer_load_ushort v126, v11, s[44:47], 0 offen
    s_cmp_eq_u32 s2, 0
    s_cselect_b32 s4, 256, s2
    s_sub_u32 s5, 512, s2
    s_cmp_eq_u32 s2, 0
    s_cselect_b32 s5, 0, s5
    s_cmp_lt_u32 s59, 4
    s_cselect_b32 s4, s4, s5
    s_lshl_b32 s4, s4, 12
    s_and_b32 s5, s59, 3
    s_lshl_b32 s5, s5, 10
    s_add_u32 s4, s4, s5
    s_add_u32 s4, s4, 11534336
    v_lshlrev_b32 v10, 4, v1
    buffer_store_dwordx4 v[22:25], v10, s[16:19], s4 offen sc1
L_recurrent_scan__spectral_fnet__mixer_gmlp__prompt_st_52:
    v_mfma_f32_32x32x16_bf16 v[48:63], v[84:87], a[0:3], 0
    v_mfma_f32_32x32x16_bf16 v[64:79], v[88:91], a[0:3], 0
    s_waitcnt lgkmcnt(0)
    v_mfma_f32_32x32x16_bf16 v[32:47], v[92:95], a[4:7], v[32:47]
    ds_read_b128 v[80:83], v112 offset:0
    ds_read_b128 v[84:87], v112 offset:4096
    ds_read_b128 v[88:91], v112 offset:8192
    s_cmp_eq_u32 s66, 1
    s_cbranch_scc0 L_recurrent_scan__spectral_fnet__mixer_gmlp__prompt_st_53
    s_add_u32 m0, s65, 98304
    s_nop 0
    buffer_load_dwordx4 v104, s[20:23], s64 offen offset:0 lds
    buffer_load_dwordx4 v105, s[20:23], s64 offen offset:1024 lds
    buffer_load_dwordx4 v106, s[20:23], s64 offen offset:2048 lds
    buffer_load_dwordx4 v107, s[20:23], s64 offen offset:3072 lds
    s_add_u32 m0, s65, 102400
    s_nop 0
    buffer_load_dwordx4 v108, s[20:23], s64 offen offset:0 lds
    buffer_load_dwordx4 v109, s[20:23], s64 offen offset:1024 lds
    s_add_u32 s64, s64, 128
    v_and_b32 v10, 15, v1
    v_lshrrev_b32 v11, 4, v1
    s_lshl_b32 s4, s59, 3
    v_add_u32 v11, s4, v11
    v_and_b32 v12, 15, v11
    v_xor_b32 v12, v12, v10
    v_subrev_u32 v13, 4, v12
    v_cmp_lt_u32 vcc, 11, v12
    s_nop 1
    v_cndmask_b32 v12, v12, v13, vcc
    v_xor_b32 v14, 4, v11
    v_add_u32 v14, 4, v11
    v_and_b32 v14, 15, v14
    v_xor_b32 v14, v14, v10
    v_subrev_u32 v13, 4, v14
    v_cmp_lt_u32 vcc, 11, v14
    s_nop 1
    v_cndmask_b32 v14, v14, v13, vcc
    s_mov_b32 s7, 1408
    v_mul_lo_u32 v11, v11, s7
    v_lshl_add_u32 v12, v12, 4, v11
    v_lshl_add_u32 v14, v14, 4, v11
    v_add_u32 v14, 4608, v14
    s_lshl_b32 s4, s62, 6
    s_mul_i32 s4, s4, 1408
    s_mul_i32 s5, s63, 192
    s_add_u32 s4, s4, s5
    s_add_u32 s4, s4, 5242880
    s_lshl_b32 s5, s59, 11
    s_add_u32 m0, s5, 147456
    s_nop 0
    buffer_load_dwordx4 v12, s[16:19], s4 offen lds
    buffer_load_dwordx4 v14, s[16:19], s4 offen offset:1024 lds
    s_lshl_b32 s4, s62, 6
    s_lshl_b32 s5, s66, 5
    s_add_u32 s4, s4, s5
    v_and_b32 v10, 31, v1
    v_add_u32 v10, s4, v10
    v_lshlrev_b32 v11, 1, v10
    s_mov_b32 s44, s54
    s_mov_b32 s45, s55
    s_mov_b32 s46, 4096
    s_mov_b32 s47, 0x00020000
    buffer_load_ushort v126, v11, s[44:47], 0 offen
    s_cmp_eq_u32 s2, 0
    s_cselect_b32 s4, 256, s2
    s_sub_u32 s5, 512, s2
    s_cmp_eq_u32 s2, 0
    s_cselect_b32 s5, 0, s5
    s_cmp_lt_u32 s59, 4
    s_cselect_b32 s4, s4, s5
    s_lshl_b32 s4, s4, 12
    s_and_b32 s5, s59, 3
    s_lshl_b32 s5, s5, 10
    s_add_u32 s4, s4, s5
    s_add_u32 s4, s4, 11534336
    v_lshlrev_b32 v10, 4, v1
    buffer_store_dwordx4 v[22:25], v10, s[16:19], s4 offen sc1
L_recurrent_scan__spectral_fnet__mixer_gmlp__prompt_st_53:
    v_mfma_f32_32x32x16_bf16 v[48:63], v[96:99], a[4:7], v[48:63]
    v_mfma_f32_32x32x16_bf16 v[64:79], v[100:103], a[4:7], v[64:79]
    s_waitcnt lgkmcnt(0)
    v_mfma_f32_32x32x16_bf16 v[32:47], v[80:83], a[8:11], v[32:47]
    ds_read_b128 v[92:95], v113 offset:0
    ds_read_b128 v[96:99], v113 offset:4096
    ds_read_b128 v[100:103], v113 offset:8192
    v_mfma_f32_32x32x16_bf16 v[48:63], v[84:87], a[8:11], v[48:63]
    v_mfma_f32_32x32x16_bf16 v[64:79], v[88:91], a[8:11], v[64:79]
    s_waitcnt lgkmcnt(0)
    v_add_u32 v110, 49152, v110
    v_add_u32 v111, 49152, v111
    v_add_u32 v112, 49152, v112
    v_add_u32 v113, 49152, v113
    s_waitcnt vmcnt(10)
    s_barrier
    v_mfma_f32_32x32x16_bf16 v[32:47], v[92:95], a[12:15], v[32:47]
    ds_read_b128 v[80:83], v110 offset:0
    ds_read_b128 v[84:87], v110 offset:4096
    ds_read_b128 v[88:91], v110 offset:8192
    v_mfma_f32_32x32x16_bf16 v[48:63], v[96:99], a[12:15], v[48:63]
    v_mfma_f32_32x32x16_bf16 v[64:79], v[100:103], a[12:15], v[64:79]
    s_waitcnt lgkmcnt(0)
    v_mfma_f32_32x32x16_bf16 v[32:47], v[80:83], a[16:19], v[32:47]
    ds_read_b128 v[92:95], v111 offset:0
    ds_read_b128 v[96:99], v111 offset:4096
    ds_read_b128 v[100:103], v111 offset:8192
    s_cmp_eq_u32 s66, 0
    s_cbranch_scc0 L_recurrent_scan__spectral_fnet__mixer_gmlp__prompt_st_54
    s_add_u32 m0, s65, 0
    s_nop 0
    buffer_load_dwordx4 v104, s[20:23], s64 offen offset:0 lds
    buffer_load_dwordx4 v105, s[20:23], s64 offen offset:1024 lds
    buffer_load_dwordx4 v106, s[20:23], s64 offen offset:2048 lds
    buffer_load_dwordx4 v107, s[20:23], s64 offen offset:3072 lds
    s_add_u32 m0, s65, 4096
    s_nop 0
    buffer_load_dwordx4 v108, s[20:23], s64 offen offset:0 lds
    buffer_load_dwordx4 v109, s[20:23], s64 offen offset:1024 lds
    s_add_u32 s64, s64, 128
L_recurrent_scan__spectral_fnet__mixer_gmlp__prompt_st_54:
    v_mfma_f32_32x32x16_bf16 v[48:63], v[84:87], a[16:19], v[48:63]
    v_mfma_f32_32x32x16_bf16 v[64:79], v[88:91], a[16:19], v[64:79]
    s_waitcnt lgkmcnt(0)
    v_mfma_f32_32x32x16_bf16 v[32:47], v[92:95], a[20:23], v[32:47]
    ds_read_b128 v[80:83], v112 offset:0
    ds_read_b128 v[84:87], v112 offset:4096
    ds_read_b128 v[88:91], v112 offset:8192
    s_cmp_eq_u32 s66, 1
    s_cbranch_scc0 L_recurrent_scan__spectral_fnet__mixer_gmlp__prompt_st_55
    s_add_u32 m0, s65, 0
    s_nop 0
    buffer_load_dwordx4 v104, s[20:23], s64 offen offset:0 lds
    buffer_load_dwordx4 v105, s[20:23], s64 offen offset:1024 lds
    buffer_load_dwordx4 v106, s[20:23], s64 offen offset:2048 lds
    buffer_load_dwordx4 v107, s[20:23], s64 offen offset:3072 lds
    s_add_u32 m0, s65, 4096
    s_nop 0
    buffer_load_dwordx4 v108, s[20:23], s64 offen offset:0 lds
    buffer_load_dwordx4 v109, s[20:23], s64 offen offset:1024 lds
    s_add_u32 s64, s64, 128
L_recurrent_scan__spectral_fnet__mixer_gmlp__prompt_st_55:
    v_mfma_f32_32x32x16_bf16 v[48:63], v[96:99], a[20:23], v[48:63]
    v_mfma_f32_32x32x16_bf16 v[64:79], v[100:103], a[20:23], v[64:79]
    s_waitcnt lgkmcnt(0)
    v_mfma_f32_32x32x16_bf16 v[32:47], v[80:83], a[24:27], v[32:47]
    ds_read_b128 v[92:95], v113 offset:0
    ds_read_b128 v[96:99], v113 offset:4096
    ds_read_b128 v[100:103], v113 offset:8192
    v_mfma_f32_32x32x16_bf16 v[48:63], v[84:87], a[24:27], v[48:63]
    v_mfma_f32_32x32x16_bf16 v[64:79], v[88:91], a[24:27], v[64:79]
    s_waitcnt lgkmcnt(0)
    v_add_u32 v110, 49152, v110
    v_add_u32 v111, 49152, v111
    v_add_u32 v112, 49152, v112
    v_add_u32 v113, 49152, v113
    s_waitcnt vmcnt(10)
    s_barrier
    v_mfma_f32_32x32x16_bf16 v[32:47], v[92:95], a[28:31], v[32:47]
    ds_read_b128 v[80:83], v110 offset:0
    ds_read_b128 v[84:87], v110 offset:4096
    ds_read_b128 v[88:91], v110 offset:8192
    v_mfma_f32_32x32x16_bf16 v[48:63], v[96:99], a[28:31], v[48:63]
    v_mfma_f32_32x32x16_bf16 v[64:79], v[100:103], a[28:31], v[64:79]
    s_waitcnt lgkmcnt(0)
    v_mfma_f32_32x32x16_bf16 v[32:47], v[80:83], a[32:35], v[32:47]
    ds_read_b128 v[92:95], v111 offset:0
    ds_read_b128 v[96:99], v111 offset:4096
    ds_read_b128 v[100:103], v111 offset:8192
    s_cmp_eq_u32 s66, 0
    s_cbranch_scc0 L_recurrent_scan__spectral_fnet__mixer_gmlp__prompt_st_56
    s_add_u32 m0, s65, 49152
    s_nop 0
    buffer_load_dwordx4 v104, s[20:23], s64 offen offset:0 lds
    buffer_load_dwordx4 v105, s[20:23], s64 offen offset:1024 lds
    buffer_load_dwordx4 v106, s[20:23], s64 offen offset:2048 lds
    buffer_load_dwordx4 v107, s[20:23], s64 offen offset:3072 lds
    s_add_u32 m0, s65, 53248
    s_nop 0
    buffer_load_dwordx4 v108, s[20:23], s64 offen offset:0 lds
    buffer_load_dwordx4 v109, s[20:23], s64 offen offset:1024 lds
    s_add_u32 s64, s64, 128
L_recurrent_scan__spectral_fnet__mixer_gmlp__prompt_st_56:
    v_mfma_f32_32x32x16_bf16 v[48:63], v[84:87], a[32:35], v[48:63]
    v_mfma_f32_32x32x16_bf16 v[64:79], v[88:91], a[32:35], v[64:79]
    s_waitcnt lgkmcnt(0)
    v_mfma_f32_32x32x16_bf16 v[32:47], v[92:95], a[36:39], v[32:47]
    ds_read_b128 v[80:83], v112 offset:0
    ds_read_b128 v[84:87], v112 offset:4096
    ds_read_b128 v[88:91], v112 offset:8192
    s_cmp_eq_u32 s66, 1
    s_cbranch_scc0 L_recurrent_scan__spectral_fnet__mixer_gmlp__prompt_st_57
    s_add_u32 m0, s65, 49152
    s_nop 0
    buffer_load_dwordx4 v104, s[20:23], s64 offen offset:0 lds
    buffer_load_dwordx4 v105, s[20:23], s64 offen offset:1024 lds
    buffer_load_dwordx4 v106, s[20:23], s64 offen offset:2048 lds
    buffer_load_dwordx4 v107, s[20:23], s64 offen offset:3072 lds
    s_add_u32 m0, s65, 53248
    s_nop 0
    buffer_load_dwordx4 v108, s[20:23], s64 offen offset:0 lds
    buffer_load_dwordx4 v109, s[20:23], s64 offen offset:1024 lds
    s_add_u32 s64, s64, 128
L_recurrent_scan__spectral_fnet__mixer_gmlp__prompt_st_57:
    v_mfma_f32_32x32x16_bf16 v[48:63], v[96:99], a[36:39], v[48:63]
    v_mfma_f32_32x32x16_bf16 v[64:79], v[100:103], a[36:39], v[64:79]
    s_waitcnt lgkmcnt(0)
    v_mfma_f32_32x32x16_bf16 v[32:47], v[80:83], a[40:43], v[32:47]
    ds_read_b128 v[92:95], v113 offset:0
    ds_read_b128 v[96:99], v113 offset:4096
    ds_read_b128 v[100:103], v113 offset:8192
    v_mfma_f32_32x32x16_bf16 v[48:63], v[84:87], a[40:43], v[48:63]
    v_mfma_f32_32x32x16_bf16 v[64:79], v[88:91], a[40:43], v[64:79]
    s_waitcnt lgkmcnt(0)
    v_add_u32 v110, 4294868992, v110
    v_add_u32 v111, 4294868992, v111
    v_add_u32 v112, 4294868992, v112
    v_add_u32 v113, 4294868992, v113
    s_waitcnt vmcnt(6)
    s_barrier
    s_lshl_b32 s4, s2, 7
    s_add_u32 s4, s4, 81920
    s_cmp_lg_u32 s59, 0
    s_cbranch_scc1 L_recurrent_scan__spectral_fnet__mixer_gmlp__prompt_fl_58
    v_mov_b32 v10, s58
    v_mov_b32 v11, s4
    s_mov_b64 exec, 1
    buffer_store_dword v10, v11, s[16:19], 0 offen sc1
    s_mov_b64 exec, -1
L_recurrent_scan__spectral_fnet__mixer_gmlp__prompt_fl_58:
    v_mfma_f32_32x32x16_bf16 v[32:47], v[92:95], a[44:47], v[32:47]
    ds_read_b128 v[80:83], v110 offset:0
    ds_read_b128 v[84:87], v110 offset:4096
    ds_read_b128 v[88:91], v110 offset:8192
    v_mfma_f32_32x32x16_bf16 v[48:63], v[96:99], a[44:47], v[48:63]
    v_mfma_f32_32x32x16_bf16 v[64:79], v[100:103], a[44:47], v[64:79]
    s_waitcnt lgkmcnt(0)
    v_mfma_f32_32x32x16_bf16 v[32:47], v[80:83], a[48:51], v[32:47]
    ds_read_b128 v[92:95], v111 offset:0
    ds_read_b128 v[96:99], v111 offset:4096
    ds_read_b128 v[100:103], v111 offset:8192
    s_cmp_eq_u32 s66, 0
    s_cbranch_scc0 L_recurrent_scan__spectral_fnet__mixer_gmlp__prompt_st_59
    s_add_u32 m0, s65, 98304
    s_nop 0
    buffer_load_dwordx4 v104, s[20:23], s64 offen offset:0 lds
    buffer_load_dwordx4 v105, s[20:23], s64 offen offset:1024 lds
    buffer_load_dwordx4 v106, s[20:23], s64 offen offset:2048 lds
    buffer_load_dwordx4 v107, s[20:23], s64 offen offset:3072 lds
    s_add_u32 m0, s65, 102400
    s_nop 0
    buffer_load_dwordx4 v108, s[20:23], s64 offen offset:0 lds
    buffer_load_dwordx4 v109, s[20:23], s64 offen offset:1024 lds
    s_add_u32 s64, s64, 128
L_recurrent_scan__spectral_fnet__mixer_gmlp__prompt_st_59:
    v_mfma_f32_32x32x16_bf16 v[48:63], v[84:87], a[48:51], v[48:63]
    v_and_b32 v10, 31, v1
    s_lshl_b32 s4, s66, 5
    v_add_u32 v10, s4, v10
    v_mfma_f32_32x32x16_bf16 v[64:79], v[88:91], a[48:51], v[64:79]
    v_and_b32 v11, 15, v10
    v_lshlrev_b32 v10, 8, v10
    v_lshrrev_b32 v12, 5, v1
    v_lshl_add_u32 v10, v12, 3, v10
    s_waitcnt lgkmcnt(0)
    v_mfma_f32_32x32x16_bf16 v[32:47], v[92:95], a[52:55], v[32:47]
    ds_read_b128 v[80:83], v112 offset:0
    ds_read_b128 v[84:87], v112 offset:4096
    ds_read_b128 v[88:91], v112 offset:8192
    s_cmp_eq_u32 s66, 1
    s_cbranch_scc0 L_recurrent_scan__spectral_fnet__mixer_gmlp__prompt_st_60
    s_add_u32 m0, s65, 98304
    s_nop 0
    buffer_load_dwordx4 v104, s[20:23], s64 offen offset:0 lds
    buffer_load_dwordx4 v105, s[20:23], s64 offen offset:1024 lds
    buffer_load_dwordx4 v106, s[20:23], s64 offen offset:2048 lds
    buffer_load_dwordx4 v107, s[20:23], s64 offen offset:3072 lds
    s_add_u32 m0, s65, 102400
    s_nop 0
    buffer_load_dwordx4 v108, s[20:23], s64 offen offset:0 lds
    buffer_load_dwordx4 v109, s[20:23], s64 offen offset:1024 lds
    s_add_u32 s64, s64, 128
L_recurrent_scan__spectral_fnet__mixer_gmlp__prompt_st_60:
    v_mfma_f32_32x32x16_bf16 v[48:63], v[96:99], a[52:55], v[48:63]
    v_add_u32 v10, 147456, v10
    s_add_u32 s4, s67, 0
    v_xor_b32 v12, s4, v11
    v_mfma_f32_32x32x16_bf16 v[64:79], v[100:103], a[52:55], v[64:79]
    v_lshl_add_u32 v12, v12, 4, v10
    ds_read_b64 v[16:17], v12
    s_add_u32 s4, s67, 4
    v_xor_b32 v12, s4, v11
    s_waitcnt lgkmcnt(0)
    v_mfma_f32_32x32x16_bf16 v[32:47], v[80:83], a[56:59], v[32:47]
    ds_read_b128 v[92:95], v113 offset:0
    ds_read_b128 v[96:99], v113 offset:4096
    ds_read_b128 v[100:103], v113 offset:8192
    v_mfma_f32_32x32x16_bf16 v[48:63], v[84:87], a[56:59], v[48:63]
    v_lshl_add_u32 v12, v12, 4, v10
    ds_read_b64 v[18:19], v12
    s_add_u32 s4, s67, 8
    v_mfma_f32_32x32x16_bf16 v[64:79], v[88:91], a[56:59], v[64:79]
    v_xor_b32 v12, s4, v11
    v_lshl_add_u32 v12, v12, 4, v10
    ds_read_b64 v[20:21], v12
    s_waitcnt lgkmcnt(0)
    v_add_u32 v110, 49152, v110
    v_add_u32 v111, 49152, v111
    v_add_u32 v112, 49152, v112
    v_add_u32 v113, 49152, v113
    s_waitcnt vmcnt(6)
    s_barrier
    v_mfma_f32_32x32x16_bf16 v[32:47], v[92:95], a[60:63], v[32:47]
    ds_read_b128 v[80:83], v110 offset:0
    ds_read_b128 v[84:87], v110 offset:4096
    ds_read_b128 v[88:91], v110 offset:8192
    v_mfma_f32_32x32x16_bf16 v[48:63], v[96:99], a[60:63], v[48:63]
    v_mfma_f32_32x32x16_bf16 v[64:79], v[100:103], a[60:63], v[64:79]
    s_waitcnt lgkmcnt(0)
    v_mfma_f32_32x32x16_bf16 v[32:47], v[80:83], a[64:67], v[32:47]
    ds_read_b128 v[92:95], v111 offset:0
    ds_read_b128 v[96:99], v111 offset:4096
    ds_read_b128 v[100:103], v111 offset:8192
    s_cmp_eq_u32 s66, 0
    s_cbranch_scc0 L_recurrent_scan__spectral_fnet__mixer_gmlp__prompt_st_61
    s_add_u32 m0, s65, 0
    s_nop 0
    buffer_load_dwordx4 v104, s[20:23], s64 offen offset:0 lds
    buffer_load_dwordx4 v105, s[20:23], s64 offen offset:1024 lds
    buffer_load_dwordx4 v106, s[20:23], s64 offen offset:2048 lds
    buffer_load_dwordx4 v107, s[20:23], s64 offen offset:3072 lds
    s_add_u32 m0, s65, 4096
    s_nop 0
    buffer_load_dwordx4 v108, s[20:23], s64 offen offset:0 lds
    buffer_load_dwordx4 v109, s[20:23], s64 offen offset:1024 lds
    s_add_u32 s64, s64, 128
L_recurrent_scan__spectral_fnet__mixer_gmlp__prompt_st_61:
    v_mfma_f32_32x32x16_bf16 v[48:63], v[84:87], a[64:67], v[48:63]
    v_lshlrev_b32 v114, 16, v16
    v_and_b32 v115, 0xffff0000, v16
    v_lshlrev_b32 v116, 16, v17
    v_and_b32 v117, 0xffff0000, v17
    v_mul_f32 v10, v114, v114
    v_mfma_f32_32x32x16_bf16 v[64:79], v[88:91], a[64:67], v[64:79]
    v_mul_f32 v11, v115, v115
    v_mul_f32 v12, v116, v116
    v_mul_f32 v13, v117, v117
    v_fma_f32 v10, v10, v5, v4
    v_fma_f32 v11, v11, v5, v4
    v_fma_f32 v12, v12, v5, v4
    s_waitcnt lgkmcnt(0)
    v_mfma_f32_32x32x16_bf16 v[32:47], v[92:95], a[68:71], v[32:47]
    ds_read_b128 v[80:83], v112 offset:0
    ds_read_b128 v[84:87], v112 offset:4096
    ds_read_b128 v[88:91], v112 offset:8192
    s_cmp_eq_u32 s66, 1
    s_cbranch_scc0 L_recurrent_scan__spectral_fnet__mixer_gmlp__prompt_st_62
    s_add_u32 m0, s65, 0
    s_nop 0
    buffer_load_dwordx4 v104, s[20:23], s64 offen offset:0 lds
    buffer_load_dwordx4 v105, s[20:23], s64 offen offset:1024 lds
    buffer_load_dwordx4 v106, s[20:23], s64 offen offset:2048 lds
    buffer_load_dwordx4 v107, s[20:23], s64 offen offset:3072 lds
    s_add_u32 m0, s65, 4096
    s_nop 0
    buffer_load_dwordx4 v108, s[20:23], s64 offen offset:0 lds
    buffer_load_dwordx4 v109, s[20:23], s64 offen offset:1024 lds
    s_add_u32 s64, s64, 128
L_recurrent_scan__spectral_fnet__mixer_gmlp__prompt_st_62:
    v_mfma_f32_32x32x16_bf16 v[48:63], v[96:99], a[68:71], v[48:63]
    v_fma_f32 v13, v13, v5, v4
    v_mul_f32 v10, v10, v114
    v_mul_f32 v11, v11, v115
    v_mul_f32 v12, v12, v116
    v_mul_f32 v13, v13, v117
    v_mfma_f32_32x32x16_bf16 v[64:79], v[100:103], a[68:71], v[64:79]
    v_exp_f32 v10, v10
    v_exp_f32 v11, v11
    v_exp_f32 v12, v12
    v_exp_f32 v13, v13
    v_add_f32 v10, 1.0, v10
    v_add_f32 v11, 1.0, v11
    s_waitcnt lgkmcnt(0)
    v_mfma_f32_32x32x16_bf16 v[32:47], v[80:83], a[72:75], v[32:47]
    ds_read_b128 v[92:95], v113 offset:0
    ds_read_b128 v[96:99], v113 offset:4096
    ds_read_b128 v[100:103], v113 offset:8192
    v_mfma_f32_32x32x16_bf16 v[48:63], v[84:87], a[72:75], v[48:63]
    v_add_f32 v12, 1.0, v12
    v_add_f32 v13, 1.0, v13
    v_rcp_f32 v10, v10
    v_rcp_f32 v11, v11
    v_rcp_f32 v12, v12
    v_mfma_f32_32x32x16_bf16 v[64:79], v[88:91], a[72:75], v[64:79]
    v_rcp_f32 v13, v13
    v_mul_f32 v114, v114, v10
    v_mul_f32 v115, v115, v11
    v_mul_f32 v116, v116, v12
    v_mul_f32 v117, v117, v13
    s_waitcnt lgkmcnt(0)
    v_add_u32 v110, 49152, v110
    v_add_u32 v111, 49152, v111
    v_add_u32 v112, 49152, v112
    v_add_u32 v113, 49152, v113
    s_waitcnt vmcnt(6)
    s_barrier
    v_mfma_f32_32x32x16_bf16 v[32:47], v[92:95], a[76:79], v[32:47]
    ds_read_b128 v[80:83], v110 offset:0
    ds_read_b128 v[84:87], v110 offset:4096
    ds_read_b128 v[88:91], v110 offset:8192
    v_mfma_f32_32x32x16_bf16 v[48:63], v[96:99], a[76:79], v[48:63]
    v_mfma_f32_32x32x16_bf16 v[64:79], v[100:103], a[76:79], v[64:79]
    s_waitcnt lgkmcnt(0)
    v_mfma_f32_32x32x16_bf16 v[32:47], v[80:83], a[80:83], v[32:47]
    ds_read_b128 v[92:95], v111 offset:0
    ds_read_b128 v[96:99], v111 offset:4096
    ds_read_b128 v[100:103], v111 offset:8192
    s_cmp_eq_u32 s66, 0
    s_cbranch_scc0 L_recurrent_scan__spectral_fnet__mixer_gmlp__prompt_st_63
    s_add_u32 m0, s65, 49152
    s_nop 0
    buffer_load_dwordx4 v104, s[20:23], s64 offen offset:0 lds
    buffer_load_dwordx4 v105, s[20:23], s64 offen offset:1024 lds
    buffer_load_dwordx4 v106, s[20:23], s64 offen offset:2048 lds
    buffer_load_dwordx4 v107, s[20:23], s64 offen offset:3072 lds
    s_add_u32 m0, s65, 53248
    s_nop 0
    buffer_load_dwordx4 v108, s[20:23], s64 offen offset:0 lds
    buffer_load_dwordx4 v109, s[20:23], s64 offen offset:1024 lds
    s_add_u32 s64, s64, 128
L_recurrent_scan__spectral_fnet__mixer_gmlp__prompt_st_63:
    v_mfma_f32_32x32x16_bf16 v[48:63], v[84:87], a[80:83], v[48:63]
    v_lshlrev_b32 v118, 16, v18
    v_and_b32 v119, 0xffff0000, v18
    v_lshlrev_b32 v120, 16, v19
    v_and_b32 v121, 0xffff0000, v19
    v_mul_f32 v10, v118, v118
    v_mul_f32 v11, v119, v119
    v_mul_f32 v12, v120, v120
    v_mfma_f32_32x32x16_bf16 v[64:79], v[88:91], a[80:83], v[64:79]
    v_mul_f32 v13, v121, v121
    v_fma_f32 v10, v10, v5, v4
    v_fma_f32 v11, v11, v5, v4
    v_fma_f32 v12, v12, v5, v4
    v_fma_f32 v13, v13, v5, v4
    v_mul_f32 v10, v10, v118
    v_mul_f32 v11, v11, v119
    v_mul_f32 v12, v12, v120
    s_waitcnt lgkmcnt(0)
    v_mfma_f32_32x32x16_bf16 v[32:47], v[92:95], a[84:87], v[32:47]
    ds_read_b128 v[80:83], v112 offset:0
    ds_read_b128 v[84:87], v112 offset:4096
    ds_read_b128 v[88:91], v112 offset:8192
    s_cmp_eq_u32 s66, 1
    s_cbranch_scc0 L_recurrent_scan__spectral_fnet__mixer_gmlp__prompt_st_64
    s_add_u32 m0, s65, 49152
    s_nop 0
    buffer_load_dwordx4 v104, s[20:23], s64 offen offset:0 lds
    buffer_load_dwordx4 v105, s[20:23], s64 offen offset:1024 lds
    buffer_load_dwordx4 v106, s[20:23], s64 offen offset:2048 lds
    buffer_load_dwordx4 v107, s[20:23], s64 offen offset:3072 lds
    s_add_u32 m0, s65, 53248
    s_nop 0
    buffer_load_dwordx4 v108, s[20:23], s64 offen offset:0 lds
    buffer_load_dwordx4 v109, s[20:23], s64 offen offset:1024 lds
    s_add_u32 s64, s64, 128
L_recurrent_scan__spectral_fnet__mixer_gmlp__prompt_st_64:
    v_mfma_f32_32x32x16_bf16 v[48:63], v[96:99], a[84:87], v[48:63]
    v_mul_f32 v13, v13, v121
    v_exp_f32 v10, v10
    v_exp_f32 v11, v11
    v_exp_f32 v12, v12
    v_exp_f32 v13, v13
    v_add_f32 v10, 1.0, v10
    v_add_f32 v11, 1.0, v11
    v_mfma_f32_32x32x16_bf16 v[64:79], v[100:103], a[84:87], v[64:79]
    v_add_f32 v12, 1.0, v12
    v_add_f32 v13, 1.0, v13
    v_rcp_f32 v10, v10
    v_rcp_f32 v11, v11
    v_rcp_f32 v12, v12
    v_rcp_f32 v13, v13
    v_mul_f32 v118, v118, v10
    v_mul_f32 v119, v119, v11
    s_waitcnt lgkmcnt(0)
    v_mfma_f32_32x32x16_bf16 v[32:47], v[80:83], a[88:91], v[32:47]
    ds_read_b128 v[92:95], v113 offset:0
    ds_read_b128 v[96:99], v113 offset:4096
    ds_read_b128 v[100:103], v113 offset:8192
    v_mfma_f32_32x32x16_bf16 v[48:63], v[84:87], a[88:91], v[48:63]
    v_mul_f32 v120, v120, v12
    v_mul_f32 v121, v121, v13
    v_lshlrev_b32 v126, 16, v126
    v_and_b32 v10, 7, v1
    v_lshrrev_b32 v11, 4, v1
    v_and_b32 v11, 1, v11
    v_mfma_f32_32x32x16_bf16 v[64:79], v[88:91], a[88:91], v[64:79]
    v_lshlrev_b32 v11, 2, v11
    v_xor_b32 v10, v10, v11
    v_lshrrev_b32 v11, 3, v1
    v_lshlrev_b32 v11, 10, v11
    v_lshl_add_u32 v127, v10, 4, v11
    s_lshl_b32 s4, s63, 7
    v_add_u32 v127, s4, v127
    s_waitcnt lgkmcnt(0)
    v_add_u32 v110, 4294868992, v110
    v_add_u32 v111, 4294868992, v111
    v_add_u32 v112, 4294868992, v112
    v_add_u32 v113, 4294868992, v113
    s_waitcnt vmcnt(6)
    s_barrier
    v_mfma_f32_32x32x16_bf16 v[32:47], v[92:95], a[92:95], v[32:47]
    ds_read_b128 v[80:83], v110 offset:0
    ds_read_b128 v[84:87], v110 offset:4096
    ds_read_b128 v[88:91], v110 offset:8192
    v_mfma_f32_32x32x16_bf16 v[48:63], v[96:99], a[92:95], v[48:63]
    v_mfma_f32_32x32x16_bf16 v[64:79], v[100:103], a[92:95], v[64:79]
    s_waitcnt lgkmcnt(0)
    v_mfma_f32_32x32x16_bf16 v[32:47], v[80:83], a[96:99], v[32:47]
    ds_read_b128 v[92:95], v111 offset:0
    ds_read_b128 v[96:99], v111 offset:4096
    ds_read_b128 v[100:103], v111 offset:8192
    s_cmp_eq_u32 s66, 0
    s_cbranch_scc0 L_recurrent_scan__spectral_fnet__mixer_gmlp__prompt_st_65
    s_lshl_b32 s4, s59, 13
    s_lshl_b32 s5, s59, 10
    s_add_u32 s7, s4, 0
    s_add_u32 m0, s5, 98304
    s_nop 0
    buffer_load_dwordx4 v127, s[32:35], s7 offen lds
    s_add_u32 s7, s4, 65536
    s_add_u32 m0, s5, 106496
    s_nop 0
    buffer_load_dwordx4 v127, s[32:35], s7 offen lds
    s_add_u32 s7, s4, 131072
    s_add_u32 m0, s5, 114688
    s_nop 0
    buffer_load_dwordx4 v127, s[32:35], s7 offen lds
    s_add_u32 s7, s4, 196608
    s_add_u32 m0, s5, 122880
    s_nop 0
    buffer_load_dwordx4 v127, s[32:35], s7 offen lds
    s_add_u32 s7, s4, 262144
    s_add_u32 m0, s5, 131072
    s_nop 0
    buffer_load_dwordx4 v127, s[32:35], s7 offen lds
    s_add_u32 s7, s4, 327680
    s_add_u32 m0, s5, 139264
    s_nop 0
    buffer_load_dwordx4 v127, s[32:35], s7 offen lds
    s_add_u32 s7, s4, 393216
    s_add_u32 m0, s5, 147456
    s_nop 0
    buffer_load_dwordx4 v127, s[32:35], s7 offen lds
    s_add_u32 s7, s4, 458752
    s_add_u32 m0, s5, 155648
    s_nop 0
    buffer_load_dwordx4 v127, s[32:35], s7 offen lds
L_recurrent_scan__spectral_fnet__mixer_gmlp__prompt_st_65:
    v_mfma_f32_32x32x16_bf16 v[48:63], v[84:87], a[96:99], v[48:63]
    v_lshlrev_b32 v122, 16, v20
    v_and_b32 v123, 0xffff0000, v20
    v_lshlrev_b32 v124, 16, v21
    v_and_b32 v125, 0xffff0000, v21
    v_mul_f32 v10, v122, v122
    v_mfma_f32_32x32x16_bf16 v[64:79], v[88:91], a[96:99], v[64:79]
    v_mul_f32 v11, v123, v123
    v_mul_f32 v12, v124, v124
    v_mul_f32 v13, v125, v125
    v_fma_f32 v10, v10, v5, v4
    v_fma_f32 v11, v11, v5, v4
    v_fma_f32 v12, v12, v5, v4
    s_waitcnt lgkmcnt(0)
    v_mfma_f32_32x32x16_bf16 v[32:47], v[92:95], a[100:103], v[32:47]
    ds_read_b128 v[80:83], v112 offset:0
    ds_read_b128 v[84:87], v112 offset:4096
    ds_read_b128 v[88:91], v112 offset:8192
    s_cmp_eq_u32 s66, 1
    s_cbranch_scc0 L_recurrent_scan__spectral_fnet__mixer_gmlp__prompt_st_66
    s_lshl_b32 s4, s59, 13
    s_lshl_b32 s5, s59, 10
    s_add_u32 s7, s4, 0
    s_add_u32 m0, s5, 98304
    s_nop 0
    buffer_load_dwordx4 v127, s[32:35], s7 offen lds
    s_add_u32 s7, s4, 65536
    s_add_u32 m0, s5, 106496
    s_nop 0
    buffer_load_dwordx4 v127, s[32:35], s7 offen lds
    s_add_u32 s7, s4, 131072
    s_add_u32 m0, s5, 114688
    s_nop 0
    buffer_load_dwordx4 v127, s[32:35], s7 offen lds
    s_add_u32 s7, s4, 196608
    s_add_u32 m0, s5, 122880
    s_nop 0
    buffer_load_dwordx4 v127, s[32:35], s7 offen lds
    s_add_u32 s7, s4, 262144
    s_add_u32 m0, s5, 131072
    s_nop 0
    buffer_load_dwordx4 v127, s[32:35], s7 offen lds
    s_add_u32 s7, s4, 327680
    s_add_u32 m0, s5, 139264
    s_nop 0
    buffer_load_dwordx4 v127, s[32:35], s7 offen lds
    s_add_u32 s7, s4, 393216
    s_add_u32 m0, s5, 147456
    s_nop 0
    buffer_load_dwordx4 v127, s[32:35], s7 offen lds
    s_add_u32 s7, s4, 458752
    s_add_u32 m0, s5, 155648
    s_nop 0
    buffer_load_dwordx4 v127, s[32:35], s7 offen lds
L_recurrent_scan__spectral_fnet__mixer_gmlp__prompt_st_66:
    v_mfma_f32_32x32x16_bf16 v[48:63], v[96:99], a[100:103], v[48:63]
    v_fma_f32 v13, v13, v5, v4
    v_mul_f32 v10, v10, v122
    v_mul_f32 v11, v11, v123
    v_mul_f32 v12, v12, v124
    v_mul_f32 v13, v13, v125
    v_mfma_f32_32x32x16_bf16 v[64:79], v[100:103], a[100:103], v[64:79]
    v_exp_f32 v10, v10
    v_exp_f32 v11, v11
    v_exp_f32 v12, v12
    v_exp_f32 v13, v13
    v_add_f32 v10, 1.0, v10
    v_add_f32 v11, 1.0, v11
    s_waitcnt lgkmcnt(0)
    v_mfma_f32_32x32x16_bf16 v[32:47], v[80:83], a[104:107], v[32:47]
    ds_read_b128 v[92:95], v113 offset:0
    ds_read_b128 v[96:99], v113 offset:4096
    ds_read_b128 v[100:103], v113 offset:8192
    v_mfma_f32_32x32x16_bf16 v[48:63], v[84:87], a[104:107], v[48:63]
    v_add_f32 v12, 1.0, v12
    v_add_f32 v13, 1.0, v13
    v_rcp_f32 v10, v10
    v_rcp_f32 v11, v11
    v_rcp_f32 v12, v12
    v_mfma_f32_32x32x16_bf16 v[64:79], v[88:91], a[104:107], v[64:79]
    v_rcp_f32 v13, v13
    v_mul_f32 v122, v122, v10
    v_mul_f32 v123, v123, v11
    v_mul_f32 v124, v124, v12
    v_mul_f32 v125, v125, v13
    s_waitcnt lgkmcnt(0)
    v_add_u32 v110, 49152, v110
    v_add_u32 v111, 49152, v111
    v_add_u32 v112, 49152, v112
    v_add_u32 v113, 49152, v113
    s_waitcnt vmcnt(8)
    s_barrier
    v_mfma_f32_32x32x16_bf16 v[32:47], v[92:95], a[108:111], v[32:47]
    ds_read_b128 v[80:83], v110 offset:0
    ds_read_b128 v[84:87], v110 offset:4096
    ds_read_b128 v[88:91], v110 offset:8192
    v_mfma_f32_32x32x16_bf16 v[48:63], v[96:99], a[108:111], v[48:63]
    v_mfma_f32_32x32x16_bf16 v[64:79], v[100:103], a[108:111], v[64:79]
    s_waitcnt lgkmcnt(0)
    v_mfma_f32_32x32x16_bf16 v[32:47], v[80:83], a[112:115], v[32:47]
    ds_read_b128 v[92:95], v111 offset:0
    ds_read_b128 v[96:99], v111 offset:4096
    ds_read_b128 v[100:103], v111 offset:8192
    s_cmp_eq_u32 s66, 0
    s_cbranch_scc0 L_recurrent_scan__spectral_fnet__mixer_gmlp__prompt_st_67
    s_lshl_b32 s4, s59, 13
    s_lshl_b32 s5, s59, 10
    s_add_u32 s7, s4, 524288
    s_add_u32 m0, s5, 0
    s_nop 0
    buffer_load_dwordx4 v127, s[32:35], s7 offen lds
    s_add_u32 s7, s4, 589824
    s_add_u32 m0, s5, 8192
    s_nop 0
    buffer_load_dwordx4 v127, s[32:35], s7 offen lds
    s_add_u32 s7, s4, 655360
    s_add_u32 m0, s5, 16384
    s_nop 0
    buffer_load_dwordx4 v127, s[32:35], s7 offen lds
L_recurrent_scan__spectral_fnet__mixer_gmlp__prompt_st_67:
    v_mfma_f32_32x32x16_bf16 v[48:63], v[84:87], a[112:115], v[48:63]
    v_mfma_f32_32x32x16_bf16 v[64:79], v[88:91], a[112:115], v[64:79]
    s_waitcnt lgkmcnt(0)
    v_mfma_f32_32x32x16_bf16 v[32:47], v[92:95], a[116:119], v[32:47]
    ds_read_b128 v[80:83], v112 offset:0
    ds_read_b128 v[84:87], v112 offset:4096
    ds_read_b128 v[88:91], v112 offset:8192
    s_cmp_eq_u32 s66, 1
    s_cbranch_scc0 L_recurrent_scan__spectral_fnet__mixer_gmlp__prompt_st_68
    s_lshl_b32 s4, s59, 13
    s_lshl_b32 s5, s59, 10
    s_add_u32 s7, s4, 524288
    s_add_u32 m0, s5, 0
    s_nop 0
    buffer_load_dwordx4 v127, s[32:35], s7 offen lds
    s_add_u32 s7, s4, 589824
    s_add_u32 m0, s5, 8192
    s_nop 0
    buffer_load_dwordx4 v127, s[32:35], s7 offen lds
    s_add_u32 s7, s4, 655360
    s_add_u32 m0, s5, 16384
    s_nop 0
    buffer_load_dwordx4 v127, s[32:35], s7 offen lds
L_recurrent_scan__spectral_fnet__mixer_gmlp__prompt_st_68:
    v_mfma_f32_32x32x16_bf16 v[48:63], v[96:99], a[116:119], v[48:63]
    v_mfma_f32_32x32x16_bf16 v[64:79], v[100:103], a[116:119], v[64:79]
    s_waitcnt lgkmcnt(0)
    v_mfma_f32_32x32x16_bf16 v[32:47], v[80:83], a[120:123], v[32:47]
    ds_read_b128 v[92:95], v113 offset:0
    ds_read_b128 v[96:99], v113 offset:4096
    ds_read_b128 v[100:103], v113 offset:8192
    v_mfma_f32_32x32x16_bf16 v[48:63], v[84:87], a[120:123], v[48:63]
    v_mfma_f32_32x32x16_bf16 v[64:79], v[88:91], a[120:123], v[64:79]
    s_waitcnt lgkmcnt(0)
    v_mfma_f32_32x32x16_bf16 v[32:47], v[92:95], a[124:127], v[32:47]
    v_mfma_f32_32x32x16_bf16 v[48:63], v[96:99], a[124:127], v[48:63]
    v_mfma_f32_32x32x16_bf16 v[64:79], v[100:103], a[124:127], v[64:79]
    s_barrier
    v_lshlrev_b32 v10, 4, v1
    s_cmp_eq_u32 s67, 0
    s_cbranch_scc1 L_recurrent_scan__spectral_fnet__mixer_gmlp__prompt_rq_69_own
    s_sub_u32 s4, s67, 1
    s_and_b32 s4, s4, 3
    s_mul_i32 s5, s66, 12
    s_add_u32 s4, s4, s5
    s_add_u32 s4, s4, 0
    s_mul_i32 s4, s4, 3072
    v_add_u32 v11, s4, v10
    ds_write_b128 v11, v[32:35] offset:24576
    ds_write_b128 v11, v[48:51] offset:25600
    ds_write_b128 v11, v[64:67] offset:26624
    s_branch L_recurrent_scan__spectral_fnet__mixer_gmlp__prompt_rq_69_d
L_recurrent_scan__spectral_fnet__mixer_gmlp__prompt_rq_69_own:
    v_add_f32 v80, v32, v126
    v_add_f32 v81, v33, v126
    v_add_f32 v82, v34, v126
    v_add_f32 v83, v35, v126
    v_add_f32 v84, v48, v126
    v_add_f32 v85, v49, v126
    v_add_f32 v86, v50, v126
    v_add_f32 v87, v51, v126
    v_add_f32 v88, v64, v126
    v_add_f32 v89, v65, v126
    v_add_f32 v90, v66, v126
    v_add_f32 v91, v67, v126
L_recurrent_scan__spectral_fnet__mixer_gmlp__prompt_rq_69_d:
    s_cmp_eq_u32 s67, 1
    s_cbranch_scc1 L_recurrent_scan__spectral_fnet__mixer_gmlp__prompt_rq_70_own
    s_sub_u32 s4, s67, 2
    s_and_b32 s4, s4, 3
    s_mul_i32 s5, s66, 12
    s_add_u32 s4, s4, s5
    s_add_u32 s4, s4, 3
    s_mul_i32 s4, s4, 3072
    v_add_u32 v11, s4, v10
    ds_write_b128 v11, v[36:39] offset:24576
    ds_write_b128 v11, v[52:55] offset:25600
    ds_write_b128 v11, v[68:71] offset:26624
    s_branch L_recurrent_scan__spectral_fnet__mixer_gmlp__prompt_rq_70_d
L_recurrent_scan__spectral_fnet__mixer_gmlp__prompt_rq_70_own:
    v_add_f32 v80, v36, v126
    v_add_f32 v81, v37, v126
    v_add_f32 v82, v38, v126
    v_add_f32 v83, v39, v126
    v_add_f32 v84, v52, v126
    v_add_f32 v85, v53, v126
    v_add_f32 v86, v54, v126
    v_add_f32 v87, v55, v126
    v_add_f32 v88, v68, v126
    v_add_f32 v89, v69, v126
    v_add_f32 v90, v70, v126
    v_add_f32 v91, v71, v126
L_recurrent_scan__spectral_fnet__mixer_gmlp__prompt_rq_70_d:
    s_cmp_eq_u32 s67, 2
    s_cbranch_scc1 L_recurrent_scan__spectral_fnet__mixer_gmlp__prompt_rq_71_own
    s_sub_u32 s4, s67, 3
    s_and_b32 s4, s4, 3
    s_mul_i32 s5, s66, 12
    s_add_u32 s4, s4, s5
    s_add_u32 s4, s4, 6
    s_mul_i32 s4, s4, 3072
    v_add_u32 v11, s4, v10
    ds_write_b128 v11, v[40:43] offset:24576
    ds_write_b128 v11, v[56:59] offset:25600
    ds_write_b128 v11, v[72:75] offset:26624
    s_branch L_recurrent_scan__spectral_fnet__mixer_gmlp__prompt_rq_71_d
L_recurrent_scan__spectral_fnet__mixer_gmlp__prompt_rq_71_own:
    v_add_f32 v80, v40, v126
    v_add_f32 v81, v41, v126
    v_add_f32 v82, v42, v126
    v_add_f32 v83, v43, v126
    v_add_f32 v84, v56, v126
    v_add_f32 v85, v57, v126
    v_add_f32 v86, v58, v126
    v_add_f32 v87, v59, v126
    v_add_f32 v88, v72, v126
    v_add_f32 v89, v73, v126
    v_add_f32 v90, v74, v126
    v_add_f32 v91, v75, v126
L_recurrent_scan__spectral_fnet__mixer_gmlp__prompt_rq_71_d:
    s_cmp_eq_u32 s67, 3
    s_cbranch_scc1 L_recurrent_scan__spectral_fnet__mixer_gmlp__prompt_rq_72_own
    s_sub_u32 s4, s67, 4
    s_and_b32 s4, s4, 3
    s_mul_i32 s5, s66, 12
    s_add_u32 s4, s4, s5
    s_add_u32 s4, s4, 9
    s_mul_i32 s4, s4, 3072
    v_add_u32 v11, s4, v10
    ds_write_b128 v11, v[44:47] offset:24576
    ds_write_b128 v11, v[60:63] offset:25600
    ds_write_b128 v11, v[76:79] offset:26624
    s_branch L_recurrent_scan__spectral_fnet__mixer_gmlp__prompt_rq_72_d
L_recurrent_scan__spectral_fnet__mixer_gmlp__prompt_rq_72_own:
    v_add_f32 v80, v44, v126
    v_add_f32 v81, v45, v126
    v_add_f32 v82, v46, v126
    v_add_f32 v83, v47, v126
    v_add_f32 v84, v60, v126
    v_add_f32 v85, v61, v126
    v_add_f32 v86, v62, v126
    v_add_f32 v87, v63, v126
    v_add_f32 v88, v76, v126
    v_add_f32 v89, v77, v126
    v_add_f32 v90, v78, v126
    v_add_f32 v91, v79, v126
L_recurrent_scan__spectral_fnet__mixer_gmlp__prompt_rq_72_d:
    s_mul_i32 s4, s66, 12
    s_mul_i32 s5, s67, 3
    s_add_u32 s4, s4, s5
    s_mul_i32 s4, s4, 3072
    v_add_u32 v11, s4, v10
    v_and_b32 v12, 31, v1
    s_lshl_b32 s4, s66, 5
    v_add_u32 v12, s4, v12
    v_mul_u32_u24 v12, 208, v12
    v_lshrrev_b32 v13, 5, v1
    v_lshl_add_u32 v12, v13, 3, v12
    s_lshl_b32 s4, s67, 4
    s_add_u32 s4, s4, 24576
    v_add_u32 v12, s4, v12
    s_waitcnt lgkmcnt(0)
    s_barrier
    ds_read_b128 v[32:35], v11 offset:24576
    ds_read_b128 v[36:39], v11 offset:25600
    ds_read_b128 v[40:43], v11 offset:26624
    ds_read_b128 v[44:47], v11 offset:27648
    ds_read_b128 v[48:51], v11 offset:28672
    ds_read_b128 v[52:55], v11 offset:29696
    ds_read_b128 v[56:59], v11 offset:30720
    ds_read_b128 v[60:63], v11 offset:31744
    ds_read_b128 v[64:67], v11 offset:32768
    v_mul_u32_u24 v13, 43, v1
    v_lshrrev_b32 v13, 9, v13
    v_mul_u32_u24 v14, 12, v13
    v_sub_u32 v14, v1, v14
    s_lshl_b32 s4, s59, 3
    v_add_u32 v13, s4, v13
    v_mul_u32_u24 v15, 208, v13
    v_lshl_add_u32 v15, v14, 4, v15
    v_add_u32 v15, 24576, v15
    s_lshl_b32 s4, s62, 6
    v_add_u32 v13, s4, v13
    s_mov_b32 s7, 1408
    v_mul_lo_u32 v13, v13, s7
    v_lshl_add_u32 v13, v14, 4, v13
    s_mul_i32 s5, s63, 96
    v_lshl_add_u32 v14, v14, 3, s5
    v_cmp_gt_u32 vcc, 704, v14
    s_mov_b64 s[6:7], vcc
    v_cmp_gt_u32 vcc, 48, v1
    s_and_b64 s[6:7], s[6:7], vcc
    s_waitcnt lgkmcnt(6)
    v_add_f32 v80, v80, v32
    v_add_f32 v81, v81, v33
    v_add_f32 v82, v82, v34
    v_add_f32 v83, v83, v35
    v_add_f32 v84, v84, v36
    v_add_f32 v85, v85, v37
    v_add_f32 v86, v86, v38
    v_add_f32 v87, v87, v39
    v_add_f32 v88, v88, v40
    v_add_f32 v89, v89, v41
    v_add_f32 v90, v90, v42
    v_add_f32 v91, v91, v43
    s_waitcnt lgkmcnt(3)
    v_add_f32 v80, v80, v44
    v_add_f32 v81, v81, v45
    v_add_f32 v82, v82, v46
    v_add_f32 v83, v83, v47
    v_add_f32 v84, v84, v48
    v_add_f32 v85, v85, v49
    v_add_f32 v86, v86, v50
    v_add_f32 v87, v87, v51
    v_add_f32 v88, v88, v52
    v_add_f32 v89, v89, v53
    v_add_f32 v90, v90, v54
    v_add_f32 v91, v91, v55
    s_waitcnt lgkmcnt(0)
    v_add_f32 v80, v80, v56
    v_add_f32 v81, v81, v57
    v_add_f32 v82, v82, v58
    v_add_f32 v83, v83, v59
    v_add_f32 v84, v84, v60
    v_add_f32 v85, v85, v61
    v_add_f32 v86, v86, v62
    v_add_f32 v87, v87, v63
    v_add_f32 v88, v88, v64
    v_add_f32 v89, v89, v65
    v_add_f32 v90, v90, v66
    v_add_f32 v91, v91, v67
    v_mul_f32 v80, v80, v114
    v_mul_f32 v81, v81, v115
    v_mul_f32 v82, v82, v116
    v_mul_f32 v83, v83, v117
    v_mul_f32 v84, v84, v118
    v_mul_f32 v85, v85, v119
    v_mul_f32 v86, v86, v120
    v_mul_f32 v87, v87, v121
    v_mul_f32 v88, v88, v122
    v_mul_f32 v89, v89, v123
    v_mul_f32 v90, v90, v124
    v_mul_f32 v91, v91, v125
    v_cvt_pk_bf16_f32 v114, v80, v81
    v_cvt_pk_bf16_f32 v115, v82, v83
    v_cvt_pk_bf16_f32 v116, v84, v85
    v_cvt_pk_bf16_f32 v117, v86, v87
    v_cvt_pk_bf16_f32 v118, v88, v89
    v_cvt_pk_bf16_f32 v119, v90, v91
    s_barrier
    ds_write_b64 v12, v[114:115] offset:0
    ds_write_b64 v12, v[116:117] offset:64
    ds_write_b64 v12, v[118:119] offset:128
    s_waitcnt lgkmcnt(0)
    s_barrier
    ds_read_b128 v[80:83], v15
    ds_read_b128 v[84:87], v15 offset:832
    s_mul_i32 s4, s63, 192
    s_add_u32 s4, s4, 13631488
    s_waitcnt lgkmcnt(0)
    s_mov_b64 exec, s[6:7]
    buffer_store_dwordx4 v[80:83], v13, s[16:19], s4 offen sc1
    s_add_u32 s4, s4, 5632
    buffer_store_dwordx4 v[84:87], v13, s[16:19], s4 offen sc1
    s_mov_b64 exec, -1
    s_and_b32 s64, s59, 1
    s_lshr_b32 s65, s59, 1
    s_and_b32 s65, s65, 1
    s_lshr_b32 s66, s59, 2
    v_lshrrev_b32 v10, 4, v1
    v_and_b32 v11, 15, v1
    v_lshrrev_b32 v12, 1, v10
    v_lshrrev_b32 v13, 2, v11
    v_lshl_add_u32 v12, v12, 3, v13
    v_lshlrev_b32 v12, 7, v12
    v_and_b32 v10, 1, v10
    s_lshl_b32 s4, s65, 1
    v_add_u32 v10, s4, v10
    v_lshrrev_b32 v13, 3, v11
    v_lshlrev_b32 v13, 1, v13
    v_xor_b32 v10, v10, v13
    v_lshl_add_u32 v12, v10, 5, v12
    v_and_b32 v11, 3, v11
    v_lshl_add_u32 v12, v11, 3, v12
    s_mul_i32 s4, s66, 45056
    s_add_u32 s4, s4, 98304
    v_add_u32 v64, s4, v12
    v_add_u32 v67, 0, v12
    v_and_b32 v10, 7, v1
    v_lshrrev_b32 v11, 4, v1
    v_xor_b32 v10, v10, v11
    v_lshrrev_b32 v11, 3, v1
    v_mul_u32_u24 v12, 1408, v11
    s_and_b32 s4, s59, 1
    s_lshl_b32 s4, s4, 2
    v_xor_b32 v10, s4, v10
    v_lshl_add_u32 v66, v10, 4, v12
    v_and_b32 v10, 31, v1
    v_lshrrev_b32 v11, 1, v10
    v_and_b32 v11, 7, v11
    v_lshrrev_b32 v12, 5, v1
    v_xor_b32 v11, v11, v12
    v_lshlrev_b32 v10, 7, v10
    v_lshl_add_u32 v10, v11, 4, v10
    s_lshl_b32 s4, s64, 12
    s_mul_i32 s5, s66, 40960
    s_add_u32 s4, s4, s5
    v_add_u32 v10, s4, v10
    v_xor_b32 v68, 0, v10
    v_xor_b32 v69, 32, v10
    v_xor_b32 v70, 64, v10
    v_xor_b32 v71, 96, v10
    v_and_b32 v10, 31, v1
    s_lshl_b32 s4, s62, 6
    s_lshl_b32 s5, s64, 5
    s_add_u32 s4, s4, s5
    v_add_u32 v10, s4, v10
    v_lshlrev_b32 v10, 10, v10
    v_lshrrev_b32 v11, 5, v1
    v_lshl_add_u32 v65, v11, 3, v10
    s_lshl_b32 s4, s63, 7
    s_lshl_b32 s5, s65, 6
    s_add_u32 s4, s4, s5
    s_lshl_b32 s5, s66, 5
    s_add_u32 s72, s4, s5
    buffer_load_dwordx2 v[72:73], v65, s[8:11], s72 offen
    buffer_load_dwordx2 v[74:75], v65, s[8:11], s72 offen offset:16
    s_waitcnt vmcnt(2)
    s_barrier
    s_lshl_b32 s4, s2, 7
    s_add_u32 s4, s4, 114688
    s_cmp_lg_u32 s59, 0
    s_cbranch_scc1 L_recurrent_scan__spectral_fnet__mixer_gmlp__prompt_fl_73
    v_mov_b32 v10, s58
    v_mov_b32 v11, s4
    s_mov_b64 exec, 1
    buffer_store_dword v10, v11, s[16:19], 0 offen sc1
    s_mov_b64 exec, -1
L_recurrent_scan__spectral_fnet__mixer_gmlp__prompt_fl_73:
    s_cmp_eq_u32 s66, 1
    s_cbranch_scc1 L_recurrent_scan__spectral_fnet__mixer_gmlp__prompt_wf_74_1
    ds_read_b64_tr_b16 a[0:1], v64 offset:0
    ds_read_b64_tr_b16 a[2:3], v64 offset:512
    ds_read_b64_tr_b16 a[4:5], v64 offset:2048
    ds_read_b64_tr_b16 a[6:7], v64 offset:2560
    ds_read_b64_tr_b16 a[8:9], v64 offset:4096
    ds_read_b64_tr_b16 a[10:11], v64 offset:4608
    ds_read_b64_tr_b16 a[12:13], v64 offset:6144
    ds_read_b64_tr_b16 a[14:15], v64 offset:6656
    ds_read_b64_tr_b16 a[16:17], v64 offset:8192
    ds_read_b64_tr_b16 a[18:19], v64 offset:8704
    ds_read_b64_tr_b16 a[20:21], v64 offset:10240
    ds_read_b64_tr_b16 a[22:23], v64 offset:10752
    ds_read_b64_tr_b16 a[24:25], v64 offset:12288
    ds_read_b64_tr_b16 a[26:27], v64 offset:12800
    ds_read_b64_tr_b16 a[28:29], v64 offset:14336
    ds_read_b64_tr_b16 a[30:31], v64 offset:14848
    ds_read_b64_tr_b16 a[32:33], v64 offset:16384
    ds_read_b64_tr_b16 a[34:35], v64 offset:16896
    ds_read_b64_tr_b16 a[36:37], v64 offset:18432
    ds_read_b64_tr_b16 a[38:39], v64 offset:18944
    ds_read_b64_tr_b16 a[40:41], v64 offset:20480
    ds_read_b64_tr_b16 a[42:43], v64 offset:20992
    ds_read_b64_tr_b16 a[44:45], v64 offset:22528
    ds_read_b64_tr_b16 a[46:47], v64 offset:23040
    ds_read_b64_tr_b16 a[48:49], v64 offset:24576
    ds_read_b64_tr_b16 a[50:51], v64 offset:25088
    ds_read_b64_tr_b16 a[52:53], v64 offset:26624
    ds_read_b64_tr_b16 a[54:55], v64 offset:27136
    ds_read_b64_tr_b16 a[56:57], v64 offset:28672
    ds_read_b64_tr_b16 a[58:59], v64 offset:29184
    ds_read_b64_tr_b16 a[60:61], v64 offset:30720
    ds_read_b64_tr_b16 a[62:63], v64 offset:31232
    ds_read_b64_tr_b16 a[64:65], v64 offset:32768
    ds_read_b64_tr_b16 a[66:67], v64 offset:33280
    ds_read_b64_tr_b16 a[68:69], v64 offset:34816
    ds_read_b64_tr_b16 a[70:71], v64 offset:35328
    ds_read_b64_tr_b16 a[72:73], v64 offset:36864
    ds_read_b64_tr_b16 a[74:75], v64 offset:37376
    ds_read_b64_tr_b16 a[76:77], v64 offset:38912
    ds_read_b64_tr_b16 a[78:79], v64 offset:39424
    ds_read_b64_tr_b16 a[80:81], v64 offset:40960
    ds_read_b64_tr_b16 a[82:83], v64 offset:41472
    ds_read_b64_tr_b16 a[84:85], v64 offset:43008
    ds_read_b64_tr_b16 a[86:87], v64 offset:43520
    s_branch L_recurrent_scan__spectral_fnet__mixer_gmlp__prompt_wf_74_d
L_recurrent_scan__spectral_fnet__mixer_gmlp__prompt_wf_74_1:
    ds_read_b64_tr_b16 a[0:1], v64 offset:0
    ds_read_b64_tr_b16 a[2:3], v64 offset:512
    ds_read_b64_tr_b16 a[4:5], v64 offset:2048
    ds_read_b64_tr_b16 a[6:7], v64 offset:2560
    ds_read_b64_tr_b16 a[8:9], v64 offset:4096
    ds_read_b64_tr_b16 a[10:11], v64 offset:4608
    ds_read_b64_tr_b16 a[12:13], v64 offset:6144
    ds_read_b64_tr_b16 a[14:15], v64 offset:6656
    ds_read_b64_tr_b16 a[16:17], v64 offset:8192
    ds_read_b64_tr_b16 a[18:19], v64 offset:8704
    ds_read_b64_tr_b16 a[20:21], v64 offset:10240
    ds_read_b64_tr_b16 a[22:23], v64 offset:10752
    ds_read_b64_tr_b16 a[24:25], v64 offset:12288
    ds_read_b64_tr_b16 a[26:27], v64 offset:12800
    ds_read_b64_tr_b16 a[28:29], v64 offset:14336
    ds_read_b64_tr_b16 a[30:31], v64 offset:14848
    ds_read_b64_tr_b16 a[32:33], v64 offset:16384
    ds_read_b64_tr_b16 a[34:35], v64 offset:16896
    ds_read_b64_tr_b16 a[36:37], v64 offset:18432
    ds_read_b64_tr_b16 a[38:39], v64 offset:18944
    ds_read_b64_tr_b16 a[40:41], v67 offset:0
    ds_read_b64_tr_b16 a[42:43], v67 offset:512
    ds_read_b64_tr_b16 a[44:45], v67 offset:2048
    ds_read_b64_tr_b16 a[46:47], v67 offset:2560
    ds_read_b64_tr_b16 a[48:49], v67 offset:4096
    ds_read_b64_tr_b16 a[50:51], v67 offset:4608
    ds_read_b64_tr_b16 a[52:53], v67 offset:6144
    ds_read_b64_tr_b16 a[54:55], v67 offset:6656
    ds_read_b64_tr_b16 a[56:57], v67 offset:8192
    ds_read_b64_tr_b16 a[58:59], v67 offset:8704
    ds_read_b64_tr_b16 a[60:61], v67 offset:10240
    ds_read_b64_tr_b16 a[62:63], v67 offset:10752
    ds_read_b64_tr_b16 a[64:65], v67 offset:12288
    ds_read_b64_tr_b16 a[66:67], v67 offset:12800
    ds_read_b64_tr_b16 a[68:69], v67 offset:14336
    ds_read_b64_tr_b16 a[70:71], v67 offset:14848
    ds_read_b64_tr_b16 a[72:73], v67 offset:16384
    ds_read_b64_tr_b16 a[74:75], v67 offset:16896
    ds_read_b64_tr_b16 a[76:77], v67 offset:18432
    ds_read_b64_tr_b16 a[78:79], v67 offset:18944
    ds_read_b64_tr_b16 a[80:81], v67 offset:20480
    ds_read_b64_tr_b16 a[82:83], v67 offset:20992
L_recurrent_scan__spectral_fnet__mixer_gmlp__prompt_wf_74_d:
    s_waitcnt lgkmcnt(0)
    s_barrier
    s_and_b32 s4, s62, 3
    s_lshl_b32 s4, s4, 3
    v_and_b32 v10, 7, v1
    v_add_u32 v10, s4, v10
    v_lshlrev_b32 v10, 3, v10
    s_lshr_b32 s5, s62, 2
    v_add_u32 v10, s5, v10
    v_lshlrev_b32 v10, 7, v10
    v_add_u32 v10, 114688, v10
    s_lshl_b32 s4, s63, 6
    v_add_u32 v12, s4, v1
    v_sub_u32 v11, 512, v12
    v_cmp_lt_u32 vcc, 256, v12
    s_nop 1
    v_cndmask_b32 v12, v12, v11, vcc
    v_and_b32 v12, 255, v12
    v_lshlrev_b32 v12, 7, v12
    v_add_u32 v12, 81920, v12
    s_mov_b32 s6, 0
L_recurrent_scan__spectral_fnet__mixer_gmlp__prompt_ph_75:
    buffer_load_dword v11, v10, s[16:19], 0 offen sc1
    buffer_load_dword v13, v12, s[16:19], 0 offen sc1
    s_waitcnt vmcnt(0)
    v_xor_b32 v11, s58, v11
    v_xor_b32 v13, s58, v13
    v_or_b32 v11, v11, v13
    v_cmp_ne_u32 vcc, 0, v11
    s_add_u32 s6, s6, 1
    s_cmp_gt_u32 s6, 200000
    s_cbranch_scc1 L_recurrent_scan__spectral_fnet__mixer_gmlp__prompt_ph_75_d
    s_cbranch_vccnz L_recurrent_scan__spectral_fnet__mixer_gmlp__prompt_ph_75
L_recurrent_scan__spectral_fnet__mixer_gmlp__prompt_ph_75_d:
    v_and_b32 v10, 7, v1
    v_lshrrev_b32 v11, 4, v1
    v_and_b32 v11, 1, v11
    v_lshlrev_b32 v11, 2, v11
    v_xor_b32 v10, v10, v11
    v_lshrrev_b32 v11, 3, v1
    v_lshlrev_b32 v11, 12, v11
    v_lshl_add_u32 v10, v10, 4, v11
    s_lshl_b32 s4, s63, 6
    s_lshl_b32 s5, s59, 3
    s_add_u32 s4, s4, s5
    s_lshl_b32 s4, s4, 12
    s_lshl_b32 s5, s62, 7
    s_add_u32 s4, s4, s5
    s_add_u32 s4, s4, 11534336
    s_lshl_b32 s5, s59, 10
    s_add_u32 m0, s5, 90112
    s_nop 0
    buffer_load_dwordx4 v10, s[16:19], s4 offen lds
    s_lshl_b32 s4, s62, 6
    s_lshl_b32 s5, s59, 3
    s_add_u32 s4, s4, s5
    s_mul_i32 s4, s4, 1408
    s_add_u32 s4, s4, 13631488
    s_lshl_b32 s5, s59, 10
    s_add_u32 s7, s4, 0
    s_add_u32 m0, s5, 0
    s_nop 0
    buffer_load_dwordx4 v66, s[16:19], s7 offen lds
    s_add_u32 s7, s4, 768
    s_add_u32 m0, s5, 49152
    s_nop 0
    buffer_load_dwordx4 v66, s[16:19], s7 offen lds
    s_add_u32 s7, s4, 128
    s_add_u32 m0, s5, 8192
    s_nop 0
    buffer_load_dwordx4 v66, s[16:19], s7 offen lds
    s_add_u32 s7, s4, 896
    s_add_u32 m0, s5, 57344
    s_nop 0
    buffer_load_dwordx4 v66, s[16:19], s7 offen lds
    s_barrier
    s_add_u32 s7, s4, 256
    s_add_u32 m0, s5, 16384
    s_nop 0
    buffer_load_dwordx4 v66, s[16:19], s7 offen lds
    s_add_u32 s7, s4, 1024
    s_add_u32 m0, s5, 65536
    s_nop 0
    buffer_load_dwordx4 v66, s[16:19], s7 offen lds
    s_add_u32 s7, s4, 384
    s_add_u32 m0, s5, 24576
    s_nop 0
    buffer_load_dwordx4 v66, s[16:19], s7 offen lds
    s_add_u32 s7, s4, 1152
    s_add_u32 m0, s5, 73728
    s_nop 0
    buffer_load_dwordx4 v66, s[16:19], s7 offen lds
    s_add_u32 s7, s4, 512
    s_add_u32 m0, s5, 32768
    s_nop 0
    buffer_load_dwordx4 v66, s[16:19], s7 offen lds
    s_add_u32 s7, s4, 1280
    s_add_u32 m0, s5, 81920
    s_nop 0
    buffer_load_dwordx4 v66, s[16:19], s7 offen lds
    s_add_u32 s7, s4, 640
    s_add_u32 m0, s5, 40960
    s_nop 0
    buffer_load_dwordx4 v66, s[16:19], s7 offen lds
    s_waitcnt vmcnt(7)
    s_barrier
    s_cmp_eq_u32 s66, 1
    s_cbranch_scc1 L_recurrent_scan__spectral_fnet__mixer_gmlp__prompt_p3_76_0_1
    ds_read_b128 v[48:51], v68 offset:0
    ds_read_b128 v[52:55], v69 offset:0
    ds_read_b128 v[56:59], v70 offset:0
    ds_read_b128 v[60:63], v71 offset:0
    s_waitcnt lgkmcnt(3)
    v_mfma_f32_32x32x16_bf16 v[32:47], a[0:3], v[48:51], 0
    ds_read_b128 v[48:51], v68 offset:8192
    s_waitcnt lgkmcnt(3)
    v_mfma_f32_32x32x16_bf16 v[32:47], a[4:7], v[52:55], v[32:47]
    ds_read_b128 v[52:55], v69 offset:8192
    s_waitcnt lgkmcnt(3)
    v_mfma_f32_32x32x16_bf16 v[32:47], a[8:11], v[56:59], v[32:47]
    ds_read_b128 v[56:59], v70 offset:8192
    s_waitcnt lgkmcnt(3)
    v_mfma_f32_32x32x16_bf16 v[32:47], a[12:15], v[60:63], v[32:47]
    ds_read_b128 v[60:63], v71 offset:8192
    s_waitcnt lgkmcnt(3)
    v_mfma_f32_32x32x16_bf16 v[32:47], a[16:19], v[48:51], v[32:47]
    s_waitcnt lgkmcnt(2)
    v_mfma_f32_32x32x16_bf16 v[32:47], a[20:23], v[52:55], v[32:47]
    s_waitcnt lgkmcnt(1)
    v_mfma_f32_32x32x16_bf16 v[32:47], a[24:27], v[56:59], v[32:47]
    s_waitcnt lgkmcnt(0)
    v_mfma_f32_32x32x16_bf16 v[32:47], a[28:31], v[60:63], v[32:47]
    s_branch L_recurrent_scan__spectral_fnet__mixer_gmlp__prompt_p3_76_0_d
L_recurrent_scan__spectral_fnet__mixer_gmlp__prompt_p3_76_0_1:
    ds_read_b128 v[48:51], v68 offset:8192
    ds_read_b128 v[52:55], v69 offset:8192
    ds_read_b128 v[56:59], v70 offset:8192
    ds_read_b128 v[60:63], v71 offset:8192
    s_waitcnt lgkmcnt(3)
    s_nop 3
    v_mfma_f32_32x32x16_bf16 v[32:47], a[8:11], v[48:51], 0
    ds_read_b128 v[48:51], v68 offset:16384
    s_waitcnt lgkmcnt(3)
    v_mfma_f32_32x32x16_bf16 v[32:47], a[12:15], v[52:55], v[32:47]
    ds_read_b128 v[52:55], v69 offset:16384
    s_waitcnt lgkmcnt(3)
    v_mfma_f32_32x32x16_bf16 v[32:47], a[16:19], v[56:59], v[32:47]
    ds_read_b128 v[56:59], v70 offset:16384
    s_waitcnt lgkmcnt(3)
    v_mfma_f32_32x32x16_bf16 v[32:47], a[20:23], v[60:63], v[32:47]
    ds_read_b128 v[60:63], v71 offset:16384
    s_waitcnt lgkmcnt(3)
    v_mfma_f32_32x32x16_bf16 v[32:47], a[24:27], v[48:51], v[32:47]
    s_waitcnt lgkmcnt(2)
    v_mfma_f32_32x32x16_bf16 v[32:47], a[28:31], v[52:55], v[32:47]
    s_waitcnt lgkmcnt(1)
    v_mfma_f32_32x32x16_bf16 v[32:47], a[32:35], v[56:59], v[32:47]
    s_waitcnt lgkmcnt(0)
    v_mfma_f32_32x32x16_bf16 v[32:47], a[36:39], v[60:63], v[32:47]
L_recurrent_scan__spectral_fnet__mixer_gmlp__prompt_p3_76_0_d:
    s_waitcnt vmcnt(3)
    s_barrier
    s_cmp_eq_u32 s66, 1
    s_cbranch_scc1 L_recurrent_scan__spectral_fnet__mixer_gmlp__prompt_p3_76_1_1
    ds_read_b128 v[48:51], v68 offset:16384
    ds_read_b128 v[52:55], v69 offset:16384
    ds_read_b128 v[56:59], v70 offset:16384
    ds_read_b128 v[60:63], v71 offset:16384
    s_waitcnt lgkmcnt(3)
    v_mfma_f32_32x32x16_bf16 v[32:47], a[32:35], v[48:51], v[32:47]
    ds_read_b128 v[48:51], v68 offset:24576
    s_waitcnt lgkmcnt(3)
    v_mfma_f32_32x32x16_bf16 v[32:47], a[36:39], v[52:55], v[32:47]
    ds_read_b128 v[52:55], v69 offset:24576
    s_waitcnt lgkmcnt(3)
    v_mfma_f32_32x32x16_bf16 v[32:47], a[40:43], v[56:59], v[32:47]
    ds_read_b128 v[56:59], v70 offset:24576
    s_waitcnt lgkmcnt(3)
    v_mfma_f32_32x32x16_bf16 v[32:47], a[44:47], v[60:63], v[32:47]
    ds_read_b128 v[60:63], v71 offset:24576
    s_waitcnt lgkmcnt(3)
    v_mfma_f32_32x32x16_bf16 v[32:47], a[48:51], v[48:51], v[32:47]
    s_waitcnt lgkmcnt(2)
    v_mfma_f32_32x32x16_bf16 v[32:47], a[52:55], v[52:55], v[32:47]
    s_waitcnt lgkmcnt(1)
    v_mfma_f32_32x32x16_bf16 v[32:47], a[56:59], v[56:59], v[32:47]
    s_waitcnt lgkmcnt(0)
    v_mfma_f32_32x32x16_bf16 v[32:47], a[60:63], v[60:63], v[32:47]
    s_branch L_recurrent_scan__spectral_fnet__mixer_gmlp__prompt_p3_76_1_d
L_recurrent_scan__spectral_fnet__mixer_gmlp__prompt_p3_76_1_1:
    ds_read_b128 v[48:51], v68 offset:24576
    ds_read_b128 v[52:55], v69 offset:24576
    ds_read_b128 v[56:59], v70 offset:24576
    ds_read_b128 v[60:63], v71 offset:24576
    s_waitcnt lgkmcnt(3)
    v_mfma_f32_32x32x16_bf16 v[32:47], a[40:43], v[48:51], v[32:47]
    ds_read_b128 v[48:51], v68 offset:32768
    s_waitcnt lgkmcnt(3)
    v_mfma_f32_32x32x16_bf16 v[32:47], a[44:47], v[52:55], v[32:47]
    ds_read_b128 v[52:55], v69 offset:32768
    s_waitcnt lgkmcnt(3)
    v_mfma_f32_32x32x16_bf16 v[32:47], a[48:51], v[56:59], v[32:47]
    ds_read_b128 v[56:59], v70 offset:32768
    s_waitcnt lgkmcnt(3)
    v_mfma_f32_32x32x16_bf16 v[32:47], a[52:55], v[60:63], v[32:47]
    ds_read_b128 v[60:63], v71 offset:32768
    s_waitcnt lgkmcnt(3)
    v_mfma_f32_32x32x16_bf16 v[32:47], a[56:59], v[48:51], v[32:47]
    s_waitcnt lgkmcnt(2)
    v_mfma_f32_32x32x16_bf16 v[32:47], a[60:63], v[52:55], v[32:47]
    s_waitcnt lgkmcnt(1)
    v_mfma_f32_32x32x16_bf16 v[32:47], a[64:67], v[56:59], v[32:47]
    s_waitcnt lgkmcnt(0)
    v_mfma_f32_32x32x16_bf16 v[32:47], a[68:71], v[60:63], v[32:47]
L_recurrent_scan__spectral_fnet__mixer_gmlp__prompt_p3_76_1_d:
    s_waitcnt vmcnt(0)
    s_barrier
    s_cmp_eq_u32 s66, 1
    s_cbranch_scc1 L_recurrent_scan__spectral_fnet__mixer_gmlp__prompt_p3_76_2_1
    ds_read_b128 v[48:51], v68 offset:32768
    ds_read_b128 v[52:55], v69 offset:32768
    ds_read_b128 v[56:59], v70 offset:32768
    ds_read_b128 v[60:63], v71 offset:32768
    s_waitcnt lgkmcnt(3)
    v_mfma_f32_32x32x16_bf16 v[32:47], a[64:67], v[48:51], v[32:47]
    ds_read_b128 v[48:51], v68 offset:40960
    s_waitcnt lgkmcnt(3)
    v_mfma_f32_32x32x16_bf16 v[32:47], a[68:71], v[52:55], v[32:47]
    ds_read_b128 v[52:55], v69 offset:40960
    s_waitcnt lgkmcnt(3)
    v_mfma_f32_32x32x16_bf16 v[32:47], a[72:75], v[56:59], v[32:47]
    s_waitcnt lgkmcnt(2)
    v_mfma_f32_32x32x16_bf16 v[32:47], a[76:79], v[60:63], v[32:47]
    s_waitcnt lgkmcnt(1)
    v_mfma_f32_32x32x16_bf16 v[32:47], a[80:83], v[48:51], v[32:47]
    s_waitcnt lgkmcnt(0)
    v_mfma_f32_32x32x16_bf16 v[32:47], a[84:87], v[52:55], v[32:47]
    s_branch L_recurrent_scan__spectral_fnet__mixer_gmlp__prompt_p3_76_2_d
L_recurrent_scan__spectral_fnet__mixer_gmlp__prompt_p3_76_2_1:
    ds_read_b128 v[48:51], v68 offset:40960
    ds_read_b128 v[52:55], v69 offset:40960
    ds_read_b128 v[56:59], v70 offset:40960
    ds_read_b128 v[60:63], v70 offset:0
    s_waitcnt lgkmcnt(3)
    v_mfma_f32_32x32x16_bf16 v[32:47], a[72:75], v[48:51], v[32:47]
    ds_read_b128 v[48:51], v71 offset:0
    s_waitcnt lgkmcnt(3)
    v_mfma_f32_32x32x16_bf16 v[32:47], a[76:79], v[52:55], v[32:47]
    s_waitcnt lgkmcnt(2)
    v_mfma_f32_32x32x16_bf16 v[32:47], a[80:83], v[56:59], v[32:47]
    s_waitcnt lgkmcnt(1)
    v_mfma_f32_32x32x16_bf16 v[32:47], a[0:3], v[60:63], v[32:47]
    s_waitcnt lgkmcnt(0)
    v_mfma_f32_32x32x16_bf16 v[32:47], a[4:7], v[48:51], v[32:47]
L_recurrent_scan__spectral_fnet__mixer_gmlp__prompt_p3_76_2_d:
    v_lshlrev_b32 v10, 4, v1
    s_lshl_b32 s4, s59, 11
    s_add_u32 s4, s4, 98304
    v_add_u32 v11, s4, v10
    s_xor_b32 s5, s59, 4
    s_lshl_b32 s5, s5, 11
    s_add_u32 s5, s5, 98304
    v_add_u32 v12, s5, v10
    s_cmp_eq_u32 s66, 1
    s_cbranch_scc1 L_recurrent_scan__spectral_fnet__mixer_gmlp__prompt_r3_77_1
    s_nop 1
    ds_write_b128 v11, v[40:43]
    ds_write_b128 v11, v[44:47] offset:1024
    s_branch L_recurrent_scan__spectral_fnet__mixer_gmlp__prompt_r3_77_d
L_recurrent_scan__spectral_fnet__mixer_gmlp__prompt_r3_77_1:
    ds_write_b128 v11, v[32:35]
    ds_write_b128 v11, v[36:39] offset:1024
    v_mov_b32 v32, v40
    v_mov_b32 v33, v41
    v_mov_b32 v34, v42
    v_mov_b32 v35, v43
    v_mov_b32 v36, v44
    v_mov_b32 v37, v45
    v_mov_b32 v38, v46
    v_mov_b32 v39, v47
L_recurrent_scan__spectral_fnet__mixer_gmlp__prompt_r3_77_d:
    s_waitcnt lgkmcnt(0)
    s_barrier
    ds_read_b128 v[48:51], v12
    ds_read_b128 v[52:55], v12 offset:1024
    v_lshrrev_b32 v10, 4, v1
    v_and_b32 v11, 15, v1
    v_lshrrev_b32 v13, 1, v10
    v_lshrrev_b32 v14, 2, v11
    v_lshl_add_u32 v13, v13, 2, v14
    s_lshl_b32 s4, s65, 5
    s_lshl_b32 s5, s66, 4
    s_add_u32 s4, s4, s5
    v_add_u32 v13, s4, v13
    v_lshlrev_b32 v13, 7, v13
    v_and_b32 v10, 1, v10
    s_lshl_b32 s4, s64, 1
    v_add_u32 v10, s4, v10
    v_lshrrev_b32 v14, 3, v11
    v_lshlrev_b32 v14, 1, v14
    v_xor_b32 v10, v10, v14
    v_lshl_add_u32 v13, v10, 5, v13
    v_and_b32 v11, 3, v11
    v_lshl_add_u32 v13, v11, 3, v13
    v_add_u32 v13, 90112, v13
    ds_read_b64_tr_b16 v[76:77], v13
    ds_read_b64_tr_b16 v[78:79], v13 offset:1024
    s_waitcnt lgkmcnt(0)
    v_add_f32 v32, v32, v48
    v_add_f32 v33, v33, v49
    v_add_f32 v34, v34, v50
    v_add_f32 v35, v35, v51
    v_add_f32 v36, v36, v52
    v_add_f32 v37, v37, v53
    v_add_f32 v38, v38, v54
    v_add_f32 v39, v39, v55
    v_mul_f32 v80, 3216550459, v32
    v_mul_f32 v81, 3216550459, v33
    v_mul_f32 v82, 3216550459, v34
    v_mul_f32 v83, 3216550459, v35
    v_mul_f32 v84, 3216550459, v36
    v_mul_f32 v85, 3216550459, v37
    v_mul_f32 v86, 3216550459, v38
    v_mul_f32 v87, 3216550459, v39
    v_exp_f32 v80, v80
    v_exp_f32 v81, v81
    v_exp_f32 v82, v82
    v_exp_f32 v83, v83
    v_exp_f32 v84, v84
    v_exp_f32 v85, v85
    v_exp_f32 v86, v86
    v_exp_f32 v87, v87
    v_add_f32 v80, 1.0, v80
    v_add_f32 v81, 1.0, v81
    v_add_f32 v82, 1.0, v82
    v_add_f32 v83, 1.0, v83
    v_add_f32 v84, 1.0, v84
    v_add_f32 v85, 1.0, v85
    v_add_f32 v86, 1.0, v86
    v_add_f32 v87, 1.0, v87
    v_rcp_f32 v80, v80
    v_rcp_f32 v81, v81
    v_rcp_f32 v82, v82
    v_rcp_f32 v83, v83
    v_rcp_f32 v84, v84
    v_rcp_f32 v85, v85
    v_rcp_f32 v86, v86
    v_rcp_f32 v87, v87
    v_mul_f32 v32, v32, v80
    v_mul_f32 v33, v33, v81
    v_mul_f32 v34, v34, v82
    v_mul_f32 v35, v35, v83
    v_mul_f32 v36, v36, v84
    v_mul_f32 v37, v37, v85
    v_mul_f32 v38, v38, v86
    v_mul_f32 v39, v39, v87
    v_lshlrev_b32 v80, 16, v76
    v_and_b32 v81, 0xffff0000, v76
    v_lshlrev_b32 v88, 16, v72
    v_and_b32 v89, 0xffff0000, v72
    v_lshlrev_b32 v82, 16, v77
    v_and_b32 v83, 0xffff0000, v77
    v_lshlrev_b32 v90, 16, v73
    v_and_b32 v91, 0xffff0000, v73
    v_lshlrev_b32 v84, 16, v78
    v_and_b32 v85, 0xffff0000, v78
    v_lshlrev_b32 v92, 16, v74
    v_and_b32 v93, 0xffff0000, v74
    v_lshlrev_b32 v86, 16, v79
    v_and_b32 v87, 0xffff0000, v79
    v_lshlrev_b32 v94, 16, v75
    v_and_b32 v95, 0xffff0000, v75
    v_fma_f32 v32, v80, v32, v88
    v_fma_f32 v33, v81, v33, v89
    v_fma_f32 v34, v82, v34, v90
    v_fma_f32 v35, v83, v35, v91
    v_fma_f32 v36, v84, v36, v92
    v_fma_f32 v37, v85, v37, v93
    v_fma_f32 v38, v86, v38, v94
    v_fma_f32 v39, v87, v39, v95
    v_cvt_pk_bf16_f32 v80, v32, v33
    v_cvt_pk_bf16_f32 v81, v34, v35
    v_cvt_pk_bf16_f32 v82, v36, v37
    v_cvt_pk_bf16_f32 v83, v38, v39
    buffer_store_dwordx2 v[80:81], v65, s[28:31], s72 offen
    buffer_store_dwordx2 v[82:83], v65, s[28:31], s72 offen offset:16
    s_waitcnt vmcnt(0)
    s_cmp_lg_u32 s2, 0
    s_cbranch_scc1 L_recurrent_scan__spectral_fnet__mixer_gmlp__prompt_ef_78_x
    s_cmp_lg_u32 s59, 0
    s_cbranch_scc1 L_recurrent_scan__spectral_fnet__mixer_gmlp__prompt_ef_78_x
    v_and_b32 v10, 63, v0
    v_lshlrev_b32 v10, 7, v10
    v_add_u32 v10, 81920, v10
    s_mov_b32 s6, 0
L_recurrent_scan__spectral_fnet__mixer_gmlp__prompt_ef_78:
    buffer_load_dword v11, v10, s[16:19], 0 offen sc1
    s_mov_b32 s4, 8192
    buffer_load_dword v12, v10, s[16:19], s4 offen sc1
    s_mov_b32 s4, 16384
    buffer_load_dword v13, v10, s[16:19], s4 offen sc1
    s_mov_b32 s4, 24576
    buffer_load_dword v14, v10, s[16:19], s4 offen sc1
    s_waitcnt vmcnt(0)
    v_xor_b32 v11, s58, v11
    v_xor_b32 v12, s58, v12
    v_xor_b32 v13, s58, v13
    v_xor_b32 v14, s58, v14
    v_or_b32 v11, v11, v12
    v_or_b32 v13, v13, v14
    v_or_b32 v11, v11, v13
    v_cmp_ne_u32 vcc, 0, v11
    s_add_u32 s6, s6, 1
    s_cmp_gt_u32 s6, 200000
    s_cbranch_scc1 L_recurrent_scan__spectral_fnet__mixer_gmlp__prompt_ef_78_x
    s_cbranch_vccnz L_recurrent_scan__spectral_fnet__mixer_gmlp__prompt_ef_78
    s_mov_b64 exec, 1
    v_mov_b32 v10, 0
    v_mov_b32 v11, s58
    buffer_store_dword v11, v10, s[16:19], 0 offen sc1
L_recurrent_scan__spectral_fnet__mixer_gmlp__prompt_ef_78_x:
    s_waitcnt vmcnt(0)
L_end:
    s_endpgm
.section .rodata,"a"
.p2align 6
.amdhsa_kernel recurrent_scan__spectral_fnet__mixer_gmlp__prompt_kernel
  .amdhsa_next_free_vgpr 256
  .amdhsa_next_free_sgpr 102
  .amdhsa_accum_offset 128
  .amdhsa_group_segment_fixed_size 0
  .amdhsa_kernarg_size 104
  .amdhsa_user_sgpr_count 2
  .amdhsa_user_sgpr_kernarg_segment_ptr 1
  .amdhsa_system_sgpr_workgroup_id_x 1
.end_amdhsa_kernel
```
